```python
import torch

def _softmax(x, axis=-1):
    return torch.softmax(x, dim=axis)
def _gelu(x):
    return torch.nn.functional.gelu(x, approximate="tanh")
def _silu(x):
    return torch.nn.functional.silu(x)
def _sigmoid(x):
    return torch.sigmoid(x)
def _layernorm(x, axis=-1, eps=1e-5):
    m = x.mean(dim=axis, keepdim=True)
    v = x.var(dim=axis, keepdim=True, unbiased=False)
    return (x - m) / torch.sqrt(v + eps)
def _scatter_add(tgt, idx, src, axis=0):
    return tgt.clone().index_add_(axis, idx, src)
def _segment_sum(src, seg, n):
    out = torch.zeros((n,) + src.shape[1:], dtype=src.dtype)
    return out.index_add_(0, seg, src)
def _pad(x, pw):
    flat = tuple(v for pair in reversed(pw) for v in pair)
    return torch.nn.functional.pad(x, flat)

kernel_name = 'concat_heads__gqa_block_cached__gqa_block_cached__decode'

def setup_inputs():

    _w = (lambda a: (lambda t: t.to(torch.bfloat16) if t.is_floating_point() else t)(torch.as_tensor(a)))
    def _A_setup():
        B, Sq, D = 1, 1, 512
        Hq, Hkv, Sk, Dh = 32, 32, 4096, 128
        assert Hq % Hkv == 0, (Hq, Hkv)
        return {
            "x": _w((lambda *s: torch.randn(*s, dtype=torch.bfloat16) * 0.8)(B, Sq, D)),
            "k_cache": _w((lambda *s: torch.randn(*s, dtype=torch.bfloat16) * 1.6)(B, Hkv, Sk, Dh)),
            "v_cache": _w((lambda *s: torch.randn(*s, dtype=torch.bfloat16) * 0.2)(B, Hkv, Sk, Dh)),
            "wq": _w((lambda *s: torch.randn(*s, dtype=torch.bfloat16) * 1.6)(D, Hq * Dh) * (D ** -0.5)),
            "wo": _w((lambda *s: torch.randn(*s, dtype=torch.bfloat16) * 0.2)(Hq * Dh, D) * ((Hq * Dh) ** -0.5)),
        }
    _A_in = _A_setup()

    def _B_setup():
        B, Sq, D = 1, 1, 512
        Hq, Hkv, Sk, Dh = 32, 32, 4096, 128
        assert Hq % Hkv == 0, (Hq, Hkv)
        return {
            "x": _w((lambda *s: torch.randn(*s, dtype=torch.bfloat16) * 0.8)(B, Sq, D)),
            "k_cache": _w((lambda *s: torch.randn(*s, dtype=torch.bfloat16) * 1.6)(B, Hkv, Sk, Dh)),
            "v_cache": _w((lambda *s: torch.randn(*s, dtype=torch.bfloat16) * 0.2)(B, Hkv, Sk, Dh)),
            "wq": _w((lambda *s: torch.randn(*s, dtype=torch.bfloat16) * 1.6)(D, Hq * Dh) * (D ** -0.5)),
            "wo": _w((lambda *s: torch.randn(*s, dtype=torch.bfloat16) * 0.2)(Hq * Dh, D) * ((Hq * Dh) ** -0.5)),
        }
    _B_in = _B_setup()

    return {
        "A_x": _A_in["x"],
        "A_k_cache": _A_in["k_cache"],
        "A_v_cache": _A_in["v_cache"],
        "A_wq": _A_in["wq"],
        "A_wo": _A_in["wo"],
        "B_x": _B_in["x"],
        "B_k_cache": _B_in["k_cache"],
        "B_v_cache": _B_in["v_cache"],
        "B_wq": _B_in["wq"],
        "B_wo": _B_in["wo"],
    }

def reference(A_x, A_k_cache, A_v_cache, A_wq, A_wo, B_x, B_k_cache, B_v_cache, B_wq, B_wo):
    def _A_ref(x, k_cache, v_cache, wq, wo):
        B, Sq, D = x.shape
        Hq, Dh = 32, 128
        Hkv = k_cache.shape[1]
        rep = Hq // Hkv
        q = (lambda x, *d: x.permute(*d))((x @ wq).reshape(B, Sq, Hq, Dh), 0, 2, 1, 3)
        k = (lambda x, n, axis: torch.repeat_interleave(x, n, dim=axis))(k_cache, rep, axis=1)
        v = (lambda x, n, axis: torch.repeat_interleave(x, n, dim=axis))(v_cache, rep, axis=1)
        scores = torch.einsum("bhqd,bhkd->bhqk", q, k) * (Dh ** -0.5)
        p = _softmax(scores, axis=-1)
        o = torch.einsum("bhqk,bhkd->bhqd", p, v)
        return (lambda x, *d: x.permute(*d))(o, 0, 2, 1, 3).reshape(B, Sq, Hq * Dh) @ wo

    def _B_ref(x, k_cache, v_cache, wq, wo):
        B, Sq, D = x.shape
        Hq, Dh = 32, 128
        Hkv = k_cache.shape[1]
        rep = Hq // Hkv
        q = (lambda x, *d: x.permute(*d))((x @ wq).reshape(B, Sq, Hq, Dh), 0, 2, 1, 3)
        k = (lambda x, n, axis: torch.repeat_interleave(x, n, dim=axis))(k_cache, rep, axis=1)
        v = (lambda x, n, axis: torch.repeat_interleave(x, n, dim=axis))(v_cache, rep, axis=1)
        scores = torch.einsum("bhqd,bhkd->bhqk", q, k) * (Dh ** -0.5)
        p = _softmax(scores, axis=-1)
        o = torch.einsum("bhqk,bhkd->bhqd", p, v)
        return (lambda x, *d: x.permute(*d))(o, 0, 2, 1, 3).reshape(B, Sq, Hq * Dh) @ wo

    a = _A_ref(A_x, A_k_cache, A_v_cache, A_wq, A_wo)
    b = _B_ref(B_x, B_k_cache, B_v_cache, B_wq, B_wo)
    return torch.concatenate([a, b], axis=-1)
```

```asm
; @launch grid=(256,1,1) block=(256,1,1) lds=4608
.amdgcn_target "amdgcn-amd-amdhsa--gfx950"
.text
.globl concat_heads__gqa_block_cached__gqa_block_cached__decode_kernel
.p2align 8
.type concat_heads__gqa_block_cached__gqa_block_cached__decode_kernel,@function
concat_heads__gqa_block_cached__gqa_block_cached__decode_kernel:
    s_cmp_ge_u32 s2, 256
    s_cbranch_scc1 L_end
    s_load_dwordx16 s[4:19], s[0:1], 0
    s_load_dwordx8 s[20:27], s[0:1], 64
    s_load_dwordx2 s[28:29], s[0:1], 96
    v_lshrrev_b32 v4, 6, v0
    v_and_b32 v0, 63, v0
    v_readfirstlane_b32 s63, v4
    s_lshr_b32 s65, s2, 5
    s_and_b32 s66, s2, 7
    s_lshr_b32 s62, s2, 7
    s_lshl_b32 s66, s66, 2
    s_lshr_b32 s66, 0x26403175, s66
    s_and_b32 s66, s66, 7
    s_and_b32 s65, s65, 3
    s_lshl_b32 s65, s65, 3
    s_or_b32 s60, s65, s66
    s_bfe_u32 s61, s2, 0x20003
    v_lshlrev_b32 v1, 4, v0
    v_lshrrev_b32 v4, 4, v0
    v_and_b32 v5, 15, v0
    v_lshlrev_b32 v5, 4, v5
    v_lshl_add_u32 v2, v4, 16, v5
    v_lshl_add_u32 v3, v4, 13, v5
    v_and_b32 v22, 3, v0
    v_lshlrev_b32 v22, 6, v22
    v_lshl_add_u32 v22, v4, 4, v22
    s_lshl_b32 s65, s63, 8
    s_lshl_b32 s71, s63, 20
    s_lshl_b32 s66, s60, 8
    s_add_u32 s71, s71, s66
    s_lshl_b32 s68, s60, 20
    s_lshl_b32 s66, s61, 18
    s_add_u32 s68, s68, s66
    s_lshl_b32 s66, s63, 16
    s_add_u32 s68, s68, s66
    s_lshl_b32 s69, s62, 3
    s_add_u32 s69, s69, s60
    s_mul_i32 s66, s63, 4
    s_add_u32 s69, s69, s66
    s_and_b32 s69, s69, 63
    s_lshl_b32 s69, s69, 10
    s_mov_b32 s70, s69
    s_lshl_b32 s72, s60, 17
    s_lshl_b32 s66, s63, 8
    s_add_u32 s72, s72, s66
    s_mov_b32 s34, 1024
    s_mov_b32 s35, 0x20000
    s_mov_b32 s46, 4194304
    s_mov_b32 s47, 0x20000
    s_mov_b32 s38, 33554432
    s_mov_b32 s39, 0x20000
    s_mov_b32 s42, 33554432
    s_mov_b32 s43, 0x20000
    s_mov_b32 s50, 4194304
    s_mov_b32 s51, 0x20000
    s_mov_b32 s54, 2097152
    s_mov_b32 s55, 0x20000
    s_mov_b32 s58, 256
    s_mov_b32 s59, 0x20000
    s_mov_b32 s86, 2048
    s_mov_b32 s87, 0x20000
    s_cmp_eq_u32 s62, 0
    s_waitcnt lgkmcnt(0)
    s_cselect_b64 s[32:33], s[4:5], s[14:15]
    s_cselect_b64 s[44:45], s[10:11], s[20:21]
    s_cselect_b64 s[40:41], s[8:9], s[18:19]
    s_cselect_b64 s[36:37], s[6:7], s[16:17]
    s_cselect_b64 s[48:49], s[12:13], s[22:23]
    buffer_load_dwordx4 v[44:47], v22, s[32:35], s65 offen
    buffer_load_dwordx4 v[128:131], v2, s[44:47], s71 offen nt
    s_add_u32 s71, s71, 8192
    s_add_u32 s67, s68, s70
    buffer_load_dwordx4 a[0:3], v1, s[40:43], s67 offen nt
    s_add_u32 s70, s70, 1024
    s_and_b32 s70, s70, 0xfc00
    buffer_load_dwordx4 v[132:135], v2, s[44:47], s71 offen nt
    s_add_u32 s71, s71, 8192
    s_add_u32 s67, s68, s70
    buffer_load_dwordx4 a[4:7], v1, s[40:43], s67 offen nt
    s_add_u32 s70, s70, 1024
    s_and_b32 s70, s70, 0xfc00
    buffer_load_dwordx4 v[136:139], v2, s[44:47], s71 offen nt
    s_add_u32 s71, s71, 8192
    s_add_u32 s67, s68, s70
    buffer_load_dwordx4 a[8:11], v1, s[40:43], s67 offen nt
    s_add_u32 s70, s70, 1024
    s_and_b32 s70, s70, 0xfc00
    buffer_load_dwordx4 v[140:143], v2, s[44:47], s71 offen nt
    s_add_u32 s71, s71, 8192
    s_add_u32 s67, s68, s70
    buffer_load_dwordx4 a[12:15], v1, s[40:43], s67 offen nt
    s_add_u32 s70, s70, 1024
    s_and_b32 s70, s70, 0xfc00
    buffer_load_dwordx4 v[144:147], v2, s[44:47], s71 offen nt
    s_add_u32 s71, s71, 8192
    s_add_u32 s67, s68, s70
    buffer_load_dwordx4 a[16:19], v1, s[40:43], s67 offen nt
    s_add_u32 s70, s70, 1024
    s_and_b32 s70, s70, 0xfc00
    buffer_load_dwordx4 v[148:151], v2, s[44:47], s71 offen nt
    s_add_u32 s71, s71, 8192
    s_add_u32 s67, s68, s70
    buffer_load_dwordx4 a[20:23], v1, s[40:43], s67 offen nt
    s_add_u32 s70, s70, 1024
    s_and_b32 s70, s70, 0xfc00
    buffer_load_dwordx4 v[152:155], v2, s[44:47], s71 offen nt
    s_add_u32 s71, s71, 8192
    s_add_u32 s67, s68, s70
    buffer_load_dwordx4 a[24:27], v1, s[40:43], s67 offen nt
    s_add_u32 s70, s70, 1024
    s_and_b32 s70, s70, 0xfc00
    buffer_load_dwordx4 v[156:159], v2, s[44:47], s71 offen nt
    s_add_u32 s71, s71, 204800
    s_mov_b64 s[52:53], s[28:29]
    s_mov_b64 s[56:57], s[26:27]
    s_mov_b64 s[84:85], s[24:25]
    s_lshl_b32 s64, s62, 5
    s_add_u32 s64, s64, s60
    s_lshl_b32 s64, s64, 2
    s_add_u32 s64, s64, s61
    s_lshl_b32 s64, s64, 2
    s_add_u32 s64, s64, s63
    s_lshl_b32 s77, s64, 9
    s_lshl_b32 s64, s64, 4
    s_add_u32 s64, s64, 524288
    v_add_u32 v10, s77, v1
    v_mov_b32 v26, -1
    v_mov_b32 v27, -1
    v_mov_b32 v28, -1
    v_mov_b32 v29, -1
    v_writelane_b32 v10, s64, 32
    v_and_b32 v5, 1, v0
    v_lshlrev_b32 v5, 4, v5
    s_mov_b32 s65, 0xffff
    v_lshlrev_b32 v5, v5, s65
    v_bfe_u32 v22, v0, 1, 2
    v_cmp_eq_u32 vcc, 0, v22
    s_nop 1
    v_cndmask_b32 v6, 0, v5, vcc
    v_cmp_eq_u32 vcc, 1, v22
    s_nop 1
    v_cndmask_b32 v7, 0, v5, vcc
    v_cmp_eq_u32 vcc, 2, v22
    s_nop 1
    v_cndmask_b32 v8, 0, v5, vcc
    v_cmp_eq_u32 vcc, 3, v22
    s_nop 1
    v_cndmask_b32 v9, 0, v5, vcc
    s_mov_b32 s75, 0x1000100
    s_mov_b32 s76, 0x3020302
    s_mov_b32 s73, 0x5040100
    s_mov_b32 s74, 0x7060302
    s_mov_b32 s78, 0xcccccccc
    s_mov_b32 s79, 0xcccccccc
    s_mov_b32 s80, 0xaaaaaaaa
    s_mov_b32 s81, 0xaaaaaaaa
    v_and_b32 v5, 15, v0
    v_lshlrev_b32 v40, 5, v5
    v_and_b32 v22, 16, v0
    v_add_u32 v40, v40, v22
    s_lshl_b32 s65, s63, 9
    v_add_u32 v38, s65, v40
    v_lshrrev_b32 v39, 2, v5
    v_lshlrev_b32 v39, 7, v39
    v_lshl_add_u32 v39, v4, 5, v39
    v_and_b32 v22, 3, v0
    v_lshl_add_u32 v39, v22, 3, v39
    v_add_u32 v39, 2304, v39
    v_lshrrev_b32 v23, 2, v0
    s_lshl_b32 s65, s62, 2
    s_add_u32 s65, s65, s63
    s_lshl_b32 s65, s65, 5
    v_add_u32 v23, s65, v23
    v_lshlrev_b32 v24, 4, v22
    v_lshl_add_u32 v41, v23, 11, v24
    v_lshl_add_u32 v42, v23, 6, v24
    s_lshl_b32 s82, s60, 6
    s_lshl_b32 s65, s63, 2
    v_lshl_add_u32 v43, v22, 2, v4
    v_lshl_add_u32 v43, v43, 4, s65
    s_lshl_b32 s83, s62, 10
    s_lshl_b32 s66, s60, 5
    s_add_u32 s83, s83, s66
    s_waitcnt vmcnt(15)
    v_perm_b32 v30, v44, v44, s75
    v_perm_b32 v31, v44, v44, s76
    v_perm_b32 v32, v45, v45, s75
    v_perm_b32 v33, v45, v45, s76
    v_perm_b32 v34, v46, v46, s75
    v_perm_b32 v35, v46, v46, s76
    v_perm_b32 v36, v47, v47, s75
    v_perm_b32 v37, v47, v47, s76
    s_nop 1
    v_and_b32_dpp v14, v30, v6 row_newbcast:0 row_mask:0xf bank_mask:0xf
    v_and_b32_dpp v15, v30, v7 row_newbcast:0 row_mask:0xf bank_mask:0xf
    v_and_b32_dpp v16, v30, v8 row_newbcast:0 row_mask:0xf bank_mask:0xf
    v_and_b32_dpp v17, v30, v9 row_newbcast:0 row_mask:0xf bank_mask:0xf
    s_waitcnt vmcnt(14)
    s_add_u32 s67, s68, s70
    buffer_load_dwordx4 a[28:31], v1, s[40:43], s67 offen nt
    s_add_u32 s70, s70, 1024
    s_and_b32 s70, s70, 0xfc00
    v_mfma_f32_16x16x32_bf16 v[22:25], v[14:17], v[128:131], 0
    s_waitcnt vmcnt(14)
    buffer_load_dwordx4 v[160:163], v2, s[44:47], s71 offen nt
    s_add_u32 s71, s71, 8192
    v_and_b32_dpp v18, v31, v6 row_newbcast:0 row_mask:0xf bank_mask:0xf
    v_and_b32_dpp v19, v31, v7 row_newbcast:0 row_mask:0xf bank_mask:0xf
    v_and_b32_dpp v20, v31, v8 row_newbcast:0 row_mask:0xf bank_mask:0xf
    v_and_b32_dpp v21, v31, v9 row_newbcast:0 row_mask:0xf bank_mask:0xf
    s_waitcnt vmcnt(14)
    s_add_u32 s67, s68, s70
    buffer_load_dwordx4 a[32:35], v1, s[40:43], s67 offen nt
    s_add_u32 s70, s70, 1024
    s_and_b32 s70, s70, 0xfc00
    v_mfma_f32_16x16x32_bf16 v[22:25], v[18:21], v[132:135], v[22:25]
    s_waitcnt vmcnt(14)
    buffer_load_dwordx4 v[164:167], v2, s[44:47], s71 offen nt
    s_add_u32 s71, s71, 8192
    v_and_b32_dpp v14, v32, v6 row_newbcast:0 row_mask:0xf bank_mask:0xf
    v_and_b32_dpp v15, v32, v7 row_newbcast:0 row_mask:0xf bank_mask:0xf
    v_and_b32_dpp v16, v32, v8 row_newbcast:0 row_mask:0xf bank_mask:0xf
    v_and_b32_dpp v17, v32, v9 row_newbcast:0 row_mask:0xf bank_mask:0xf
    s_waitcnt vmcnt(14)
    s_add_u32 s67, s68, s70
    buffer_load_dwordx4 a[36:39], v1, s[40:43], s67 offen nt
    s_add_u32 s70, s70, 1024
    s_and_b32 s70, s70, 0xfc00
    v_mfma_f32_16x16x32_bf16 v[22:25], v[14:17], v[136:139], v[22:25]
    s_waitcnt vmcnt(14)
    buffer_load_dwordx4 v[168:171], v2, s[44:47], s71 offen nt
    s_add_u32 s71, s71, 8192
    v_and_b32_dpp v18, v33, v6 row_newbcast:0 row_mask:0xf bank_mask:0xf
    v_and_b32_dpp v19, v33, v7 row_newbcast:0 row_mask:0xf bank_mask:0xf
    v_and_b32_dpp v20, v33, v8 row_newbcast:0 row_mask:0xf bank_mask:0xf
    v_and_b32_dpp v21, v33, v9 row_newbcast:0 row_mask:0xf bank_mask:0xf
    s_waitcnt vmcnt(14)
    s_add_u32 s67, s68, s70
    buffer_load_dwordx4 a[40:43], v1, s[40:43], s67 offen nt
    s_add_u32 s70, s70, 1024
    s_and_b32 s70, s70, 0xfc00
    v_mfma_f32_16x16x32_bf16 v[22:25], v[18:21], v[140:143], v[22:25]
    s_waitcnt vmcnt(14)
    buffer_load_dwordx4 v[172:175], v2, s[44:47], s71 offen nt
    s_add_u32 s71, s71, 8192
    v_and_b32_dpp v14, v34, v6 row_newbcast:0 row_mask:0xf bank_mask:0xf
    v_and_b32_dpp v15, v34, v7 row_newbcast:0 row_mask:0xf bank_mask:0xf
    v_and_b32_dpp v16, v34, v8 row_newbcast:0 row_mask:0xf bank_mask:0xf
    v_and_b32_dpp v17, v34, v9 row_newbcast:0 row_mask:0xf bank_mask:0xf
    s_waitcnt vmcnt(14)
    s_add_u32 s67, s68, s70
    buffer_load_dwordx4 a[44:47], v1, s[40:43], s67 offen nt
    s_add_u32 s70, s70, 1024
    s_and_b32 s70, s70, 0xfc00
    v_mfma_f32_16x16x32_bf16 v[22:25], v[14:17], v[144:147], v[22:25]
    s_waitcnt vmcnt(14)
    buffer_load_dwordx4 v[176:179], v2, s[44:47], s71 offen nt
    s_add_u32 s71, s71, 8192
    v_and_b32_dpp v18, v35, v6 row_newbcast:0 row_mask:0xf bank_mask:0xf
    v_and_b32_dpp v19, v35, v7 row_newbcast:0 row_mask:0xf bank_mask:0xf
    v_and_b32_dpp v20, v35, v8 row_newbcast:0 row_mask:0xf bank_mask:0xf
    v_and_b32_dpp v21, v35, v9 row_newbcast:0 row_mask:0xf bank_mask:0xf
    s_waitcnt vmcnt(14)
    s_add_u32 s67, s68, s70
    buffer_load_dwordx4 a[48:51], v1, s[40:43], s67 offen nt
    s_add_u32 s70, s70, 1024
    s_and_b32 s70, s70, 0xfc00
    v_mfma_f32_16x16x32_bf16 v[22:25], v[18:21], v[148:151], v[22:25]
    s_waitcnt vmcnt(14)
    buffer_load_dwordx4 v[180:183], v2, s[44:47], s71 offen nt
    s_add_u32 s71, s71, 8192
    v_and_b32_dpp v14, v36, v6 row_newbcast:0 row_mask:0xf bank_mask:0xf
    v_and_b32_dpp v15, v36, v7 row_newbcast:0 row_mask:0xf bank_mask:0xf
    v_and_b32_dpp v16, v36, v8 row_newbcast:0 row_mask:0xf bank_mask:0xf
    v_and_b32_dpp v17, v36, v9 row_newbcast:0 row_mask:0xf bank_mask:0xf
    s_waitcnt vmcnt(14)
    s_add_u32 s67, s68, s70
    buffer_load_dwordx4 a[52:55], v1, s[40:43], s67 offen nt
    s_add_u32 s70, s70, 1024
    s_and_b32 s70, s70, 0xfc00
    v_mfma_f32_16x16x32_bf16 v[22:25], v[14:17], v[152:155], v[22:25]
    s_waitcnt vmcnt(14)
    buffer_load_dwordx4 v[184:187], v2, s[44:47], s71 offen nt
    s_add_u32 s71, s71, 8192
    v_and_b32_dpp v18, v37, v6 row_newbcast:0 row_mask:0xf bank_mask:0xf
    v_and_b32_dpp v19, v37, v7 row_newbcast:0 row_mask:0xf bank_mask:0xf
    v_and_b32_dpp v20, v37, v8 row_newbcast:0 row_mask:0xf bank_mask:0xf
    v_and_b32_dpp v21, v37, v9 row_newbcast:0 row_mask:0xf bank_mask:0xf
    s_waitcnt vmcnt(14)
    s_add_u32 s67, s68, s70
    buffer_load_dwordx4 a[56:59], v1, s[40:43], s67 offen nt
    s_add_u32 s70, s70, 1024
    s_and_b32 s70, s70, 0xfc00
    v_mfma_f32_16x16x32_bf16 v[22:25], v[18:21], v[156:159], v[22:25]
    s_waitcnt vmcnt(14)
    buffer_load_dwordx4 v[188:191], v2, s[44:47], s71 offen nt
    s_add_u32 s71, s71, 204800
    v_and_b32_dpp v14, v30, v6 row_newbcast:1 row_mask:0xf bank_mask:0xf
    v_and_b32_dpp v15, v30, v7 row_newbcast:1 row_mask:0xf bank_mask:0xf
    v_and_b32_dpp v16, v30, v8 row_newbcast:1 row_mask:0xf bank_mask:0xf
    v_and_b32_dpp v17, v30, v9 row_newbcast:1 row_mask:0xf bank_mask:0xf
    s_waitcnt vmcnt(14)
    s_add_u32 s67, s68, s70
    buffer_load_dwordx4 a[60:63], v1, s[40:43], s67 offen nt
    s_add_u32 s70, s70, 1024
    s_and_b32 s70, s70, 0xfc00
    v_mfma_f32_16x16x32_bf16 v[22:25], v[14:17], v[160:163], v[22:25]
    s_waitcnt vmcnt(14)
    buffer_load_dwordx4 v[192:195], v2, s[44:47], s71 offen nt
    s_add_u32 s71, s71, 8192
    v_and_b32_dpp v18, v31, v6 row_newbcast:1 row_mask:0xf bank_mask:0xf
    v_and_b32_dpp v19, v31, v7 row_newbcast:1 row_mask:0xf bank_mask:0xf
    v_and_b32_dpp v20, v31, v8 row_newbcast:1 row_mask:0xf bank_mask:0xf
    v_and_b32_dpp v21, v31, v9 row_newbcast:1 row_mask:0xf bank_mask:0xf
    s_waitcnt vmcnt(14)
    s_add_u32 s67, s68, s70
    buffer_load_dwordx4 a[64:67], v1, s[40:43], s67 offen nt
    s_add_u32 s70, s70, 1024
    s_and_b32 s70, s70, 0xfc00
    v_mfma_f32_16x16x32_bf16 v[22:25], v[18:21], v[164:167], v[22:25]
    s_waitcnt vmcnt(14)
    buffer_load_dwordx4 v[196:199], v2, s[44:47], s71 offen nt
    s_add_u32 s71, s71, 8192
    v_and_b32_dpp v14, v32, v6 row_newbcast:1 row_mask:0xf bank_mask:0xf
    v_and_b32_dpp v15, v32, v7 row_newbcast:1 row_mask:0xf bank_mask:0xf
    v_and_b32_dpp v16, v32, v8 row_newbcast:1 row_mask:0xf bank_mask:0xf
    v_and_b32_dpp v17, v32, v9 row_newbcast:1 row_mask:0xf bank_mask:0xf
    s_waitcnt vmcnt(14)
    s_add_u32 s67, s68, s70
    buffer_load_dwordx4 a[68:71], v1, s[40:43], s67 offen nt
    s_add_u32 s70, s70, 1024
    s_and_b32 s70, s70, 0xfc00
    v_mfma_f32_16x16x32_bf16 v[22:25], v[14:17], v[168:171], v[22:25]
    s_waitcnt vmcnt(14)
    buffer_load_dwordx4 v[200:203], v2, s[44:47], s71 offen nt
    s_add_u32 s71, s71, 8192
    v_and_b32_dpp v18, v33, v6 row_newbcast:1 row_mask:0xf bank_mask:0xf
    v_and_b32_dpp v19, v33, v7 row_newbcast:1 row_mask:0xf bank_mask:0xf
    v_and_b32_dpp v20, v33, v8 row_newbcast:1 row_mask:0xf bank_mask:0xf
    v_and_b32_dpp v21, v33, v9 row_newbcast:1 row_mask:0xf bank_mask:0xf
    s_waitcnt vmcnt(14)
    s_add_u32 s67, s68, s70
    buffer_load_dwordx4 a[72:75], v1, s[40:43], s67 offen nt
    s_add_u32 s70, s70, 1024
    s_and_b32 s70, s70, 0xfc00
    v_mfma_f32_16x16x32_bf16 v[22:25], v[18:21], v[172:175], v[22:25]
    s_waitcnt vmcnt(14)
    buffer_load_dwordx4 v[204:207], v2, s[44:47], s71 offen nt
    s_add_u32 s71, s71, 8192
    v_and_b32_dpp v14, v34, v6 row_newbcast:1 row_mask:0xf bank_mask:0xf
    v_and_b32_dpp v15, v34, v7 row_newbcast:1 row_mask:0xf bank_mask:0xf
    v_and_b32_dpp v16, v34, v8 row_newbcast:1 row_mask:0xf bank_mask:0xf
    v_and_b32_dpp v17, v34, v9 row_newbcast:1 row_mask:0xf bank_mask:0xf
    s_waitcnt vmcnt(14)
    s_add_u32 s67, s68, s70
    buffer_load_dwordx4 a[76:79], v1, s[40:43], s67 offen nt
    s_add_u32 s70, s70, 1024
    s_and_b32 s70, s70, 0xfc00
    v_mfma_f32_16x16x32_bf16 v[22:25], v[14:17], v[176:179], v[22:25]
    s_waitcnt vmcnt(14)
    buffer_load_dwordx4 v[208:211], v2, s[44:47], s71 offen nt
    s_add_u32 s71, s71, 8192
    v_and_b32_dpp v18, v35, v6 row_newbcast:1 row_mask:0xf bank_mask:0xf
    v_and_b32_dpp v19, v35, v7 row_newbcast:1 row_mask:0xf bank_mask:0xf
    v_and_b32_dpp v20, v35, v8 row_newbcast:1 row_mask:0xf bank_mask:0xf
    v_and_b32_dpp v21, v35, v9 row_newbcast:1 row_mask:0xf bank_mask:0xf
    s_waitcnt vmcnt(14)
    s_add_u32 s67, s68, s70
    buffer_load_dwordx4 a[80:83], v1, s[40:43], s67 offen nt
    s_add_u32 s70, s70, 1024
    s_and_b32 s70, s70, 0xfc00
    v_mfma_f32_16x16x32_bf16 v[22:25], v[18:21], v[180:183], v[22:25]
    s_waitcnt vmcnt(14)
    buffer_load_dwordx4 v[212:215], v2, s[44:47], s71 offen nt
    s_add_u32 s71, s71, 8192
    v_and_b32_dpp v14, v36, v6 row_newbcast:1 row_mask:0xf bank_mask:0xf
    v_and_b32_dpp v15, v36, v7 row_newbcast:1 row_mask:0xf bank_mask:0xf
    v_and_b32_dpp v16, v36, v8 row_newbcast:1 row_mask:0xf bank_mask:0xf
    v_and_b32_dpp v17, v36, v9 row_newbcast:1 row_mask:0xf bank_mask:0xf
    s_waitcnt vmcnt(14)
    s_add_u32 s67, s68, s70
    buffer_load_dwordx4 a[84:87], v1, s[40:43], s67 offen nt
    s_add_u32 s70, s70, 1024
    s_and_b32 s70, s70, 0xfc00
    v_mfma_f32_16x16x32_bf16 v[22:25], v[14:17], v[184:187], v[22:25]
    s_waitcnt vmcnt(14)
    buffer_load_dwordx4 v[216:219], v2, s[44:47], s71 offen nt
    s_add_u32 s71, s71, 8192
    v_and_b32_dpp v18, v37, v6 row_newbcast:1 row_mask:0xf bank_mask:0xf
    v_and_b32_dpp v19, v37, v7 row_newbcast:1 row_mask:0xf bank_mask:0xf
    v_and_b32_dpp v20, v37, v8 row_newbcast:1 row_mask:0xf bank_mask:0xf
    v_and_b32_dpp v21, v37, v9 row_newbcast:1 row_mask:0xf bank_mask:0xf
    s_waitcnt vmcnt(14)
    s_add_u32 s67, s68, s70
    buffer_load_dwordx4 a[88:91], v1, s[40:43], s67 offen nt
    s_add_u32 s70, s70, 1024
    s_and_b32 s70, s70, 0xfc00
    v_mfma_f32_16x16x32_bf16 v[22:25], v[18:21], v[188:191], v[22:25]
    s_waitcnt vmcnt(14)
    buffer_load_dwordx4 v[220:223], v2, s[44:47], s71 offen nt
    s_add_u32 s71, s71, 204800
    v_and_b32_dpp v14, v30, v6 row_newbcast:2 row_mask:0xf bank_mask:0xf
    v_and_b32_dpp v15, v30, v7 row_newbcast:2 row_mask:0xf bank_mask:0xf
    v_and_b32_dpp v16, v30, v8 row_newbcast:2 row_mask:0xf bank_mask:0xf
    v_and_b32_dpp v17, v30, v9 row_newbcast:2 row_mask:0xf bank_mask:0xf
    s_waitcnt vmcnt(14)
    s_add_u32 s67, s68, s70
    buffer_load_dwordx4 a[92:95], v1, s[40:43], s67 offen nt
    s_add_u32 s70, s70, 1024
    s_and_b32 s70, s70, 0xfc00
    v_mfma_f32_16x16x32_bf16 v[22:25], v[14:17], v[192:195], v[22:25]
    s_waitcnt vmcnt(14)
    buffer_load_dwordx4 v[224:227], v2, s[44:47], s71 offen nt
    s_add_u32 s71, s71, 8192
    v_and_b32_dpp v18, v31, v6 row_newbcast:2 row_mask:0xf bank_mask:0xf
    v_and_b32_dpp v19, v31, v7 row_newbcast:2 row_mask:0xf bank_mask:0xf
    v_and_b32_dpp v20, v31, v8 row_newbcast:2 row_mask:0xf bank_mask:0xf
    v_and_b32_dpp v21, v31, v9 row_newbcast:2 row_mask:0xf bank_mask:0xf
    s_waitcnt vmcnt(14)
    s_add_u32 s67, s68, s70
    buffer_load_dwordx4 a[96:99], v1, s[40:43], s67 offen nt
    s_add_u32 s70, s70, 1024
    s_and_b32 s70, s70, 0xfc00
    v_mfma_f32_16x16x32_bf16 v[22:25], v[18:21], v[196:199], v[22:25]
    s_waitcnt vmcnt(14)
    buffer_load_dwordx4 v[228:231], v2, s[44:47], s71 offen nt
    s_add_u32 s71, s71, 8192
    v_and_b32_dpp v14, v32, v6 row_newbcast:2 row_mask:0xf bank_mask:0xf
    v_and_b32_dpp v15, v32, v7 row_newbcast:2 row_mask:0xf bank_mask:0xf
    v_and_b32_dpp v16, v32, v8 row_newbcast:2 row_mask:0xf bank_mask:0xf
    v_and_b32_dpp v17, v32, v9 row_newbcast:2 row_mask:0xf bank_mask:0xf
    s_waitcnt vmcnt(14)
    s_add_u32 s67, s68, s70
    buffer_load_dwordx4 a[100:103], v1, s[40:43], s67 offen nt
    s_add_u32 s70, s70, 1024
    s_and_b32 s70, s70, 0xfc00
    v_mfma_f32_16x16x32_bf16 v[22:25], v[14:17], v[200:203], v[22:25]
    s_waitcnt vmcnt(14)
    buffer_load_dwordx4 v[232:235], v2, s[44:47], s71 offen nt
    s_add_u32 s71, s71, 8192
    v_and_b32_dpp v18, v33, v6 row_newbcast:2 row_mask:0xf bank_mask:0xf
    v_and_b32_dpp v19, v33, v7 row_newbcast:2 row_mask:0xf bank_mask:0xf
    v_and_b32_dpp v20, v33, v8 row_newbcast:2 row_mask:0xf bank_mask:0xf
    v_and_b32_dpp v21, v33, v9 row_newbcast:2 row_mask:0xf bank_mask:0xf
    s_waitcnt vmcnt(14)
    s_add_u32 s67, s68, s70
    buffer_load_dwordx4 a[104:107], v1, s[40:43], s67 offen nt
    s_add_u32 s70, s70, 1024
    s_and_b32 s70, s70, 0xfc00
    v_mfma_f32_16x16x32_bf16 v[22:25], v[18:21], v[204:207], v[22:25]
    s_waitcnt vmcnt(14)
    buffer_load_dwordx4 v[236:239], v2, s[44:47], s71 offen nt
    s_add_u32 s71, s71, 8192
    v_and_b32_dpp v14, v34, v6 row_newbcast:2 row_mask:0xf bank_mask:0xf
    v_and_b32_dpp v15, v34, v7 row_newbcast:2 row_mask:0xf bank_mask:0xf
    v_and_b32_dpp v16, v34, v8 row_newbcast:2 row_mask:0xf bank_mask:0xf
    v_and_b32_dpp v17, v34, v9 row_newbcast:2 row_mask:0xf bank_mask:0xf
    s_waitcnt vmcnt(14)
    s_add_u32 s67, s68, s70
    buffer_load_dwordx4 a[108:111], v1, s[40:43], s67 offen nt
    s_add_u32 s70, s70, 1024
    s_and_b32 s70, s70, 0xfc00
    v_mfma_f32_16x16x32_bf16 v[22:25], v[14:17], v[208:211], v[22:25]
    s_waitcnt vmcnt(14)
    buffer_load_dwordx4 v[240:243], v2, s[44:47], s71 offen nt
    s_add_u32 s71, s71, 8192
    v_and_b32_dpp v18, v35, v6 row_newbcast:2 row_mask:0xf bank_mask:0xf
    v_and_b32_dpp v19, v35, v7 row_newbcast:2 row_mask:0xf bank_mask:0xf
    v_and_b32_dpp v20, v35, v8 row_newbcast:2 row_mask:0xf bank_mask:0xf
    v_and_b32_dpp v21, v35, v9 row_newbcast:2 row_mask:0xf bank_mask:0xf
    s_waitcnt vmcnt(14)
    s_add_u32 s67, s68, s70
    buffer_load_dwordx4 a[112:115], v1, s[40:43], s67 offen nt
    s_add_u32 s70, s70, 1024
    s_and_b32 s70, s70, 0xfc00
    v_mfma_f32_16x16x32_bf16 v[22:25], v[18:21], v[212:215], v[22:25]
    s_waitcnt vmcnt(14)
    buffer_load_dwordx4 v[244:247], v2, s[44:47], s71 offen nt
    s_add_u32 s71, s71, 8192
    v_and_b32_dpp v14, v36, v6 row_newbcast:2 row_mask:0xf bank_mask:0xf
    v_and_b32_dpp v15, v36, v7 row_newbcast:2 row_mask:0xf bank_mask:0xf
    v_and_b32_dpp v16, v36, v8 row_newbcast:2 row_mask:0xf bank_mask:0xf
    v_and_b32_dpp v17, v36, v9 row_newbcast:2 row_mask:0xf bank_mask:0xf
    s_waitcnt vmcnt(14)
    s_add_u32 s67, s68, s70
    buffer_load_dwordx4 a[116:119], v1, s[40:43], s67 offen nt
    s_add_u32 s70, s70, 1024
    s_and_b32 s70, s70, 0xfc00
    v_mfma_f32_16x16x32_bf16 v[22:25], v[14:17], v[216:219], v[22:25]
    s_waitcnt vmcnt(14)
    buffer_load_dwordx4 v[248:251], v2, s[44:47], s71 offen nt
    s_add_u32 s71, s71, 8192
    v_and_b32_dpp v18, v37, v6 row_newbcast:2 row_mask:0xf bank_mask:0xf
    v_and_b32_dpp v19, v37, v7 row_newbcast:2 row_mask:0xf bank_mask:0xf
    v_and_b32_dpp v20, v37, v8 row_newbcast:2 row_mask:0xf bank_mask:0xf
    v_and_b32_dpp v21, v37, v9 row_newbcast:2 row_mask:0xf bank_mask:0xf
    s_waitcnt vmcnt(14)
    s_add_u32 s67, s68, s70
    buffer_load_dwordx4 a[120:123], v1, s[40:43], s67 offen nt
    s_add_u32 s70, s70, 1024
    s_and_b32 s70, s70, 0xfc00
    v_mfma_f32_16x16x32_bf16 v[22:25], v[18:21], v[220:223], v[22:25]
    s_waitcnt vmcnt(14)
    s_mov_b32 exec_hi, 1
    buffer_store_dwordx4 v[26:29], v10, s[52:55], 0 offen sc1
    s_mov_b32 exec_hi, -1
    buffer_load_dwordx4 v[252:255], v2, s[44:47], s71 offen nt
    v_and_b32_dpp v14, v30, v6 row_newbcast:3 row_mask:0xf bank_mask:0xf
    v_and_b32_dpp v15, v30, v7 row_newbcast:3 row_mask:0xf bank_mask:0xf
    v_and_b32_dpp v16, v30, v8 row_newbcast:3 row_mask:0xf bank_mask:0xf
    v_and_b32_dpp v17, v30, v9 row_newbcast:3 row_mask:0xf bank_mask:0xf
    s_waitcnt vmcnt(15)
    s_add_u32 s67, s68, s70
    buffer_load_dwordx4 a[124:127], v1, s[40:43], s67 offen nt
    s_add_u32 s70, s70, 1024
    s_and_b32 s70, s70, 0xfc00
    v_mfma_f32_16x16x32_bf16 v[22:25], v[14:17], v[224:227], v[22:25]
    s_waitcnt vmcnt(15)
    s_add_u32 s67, s68, s69
    buffer_load_dwordx4 v[48:51], v1, s[36:39], s67 offen nt
    s_add_u32 s69, s69, 1024
    s_and_b32 s69, s69, 0xfc00
    v_and_b32_dpp v18, v31, v6 row_newbcast:3 row_mask:0xf bank_mask:0xf
    v_and_b32_dpp v19, v31, v7 row_newbcast:3 row_mask:0xf bank_mask:0xf
    v_and_b32_dpp v20, v31, v8 row_newbcast:3 row_mask:0xf bank_mask:0xf
    v_and_b32_dpp v21, v31, v9 row_newbcast:3 row_mask:0xf bank_mask:0xf
    s_waitcnt vmcnt(15)
    s_add_u32 s67, s68, s69
    buffer_load_dwordx4 v[52:55], v1, s[36:39], s67 offen nt
    s_add_u32 s69, s69, 1024
    s_and_b32 s69, s69, 0xfc00
    v_mfma_f32_16x16x32_bf16 v[22:25], v[18:21], v[228:231], v[22:25]
    s_waitcnt vmcnt(15)
    s_add_u32 s67, s68, s69
    buffer_load_dwordx4 v[56:59], v1, s[36:39], s67 offen nt
    s_add_u32 s69, s69, 1024
    s_and_b32 s69, s69, 0xfc00
    v_and_b32_dpp v14, v32, v6 row_newbcast:3 row_mask:0xf bank_mask:0xf
    v_and_b32_dpp v15, v32, v7 row_newbcast:3 row_mask:0xf bank_mask:0xf
    v_and_b32_dpp v16, v32, v8 row_newbcast:3 row_mask:0xf bank_mask:0xf
    v_and_b32_dpp v17, v32, v9 row_newbcast:3 row_mask:0xf bank_mask:0xf
    s_waitcnt vmcnt(15)
    s_add_u32 s67, s68, s69
    buffer_load_dwordx4 v[60:63], v1, s[36:39], s67 offen nt
    s_add_u32 s69, s69, 1024
    s_and_b32 s69, s69, 0xfc00
    v_mfma_f32_16x16x32_bf16 v[22:25], v[14:17], v[232:235], v[22:25]
    s_waitcnt vmcnt(15)
    s_add_u32 s67, s68, s69
    buffer_load_dwordx4 v[64:67], v1, s[36:39], s67 offen nt
    s_add_u32 s69, s69, 1024
    s_and_b32 s69, s69, 0xfc00
    v_and_b32_dpp v18, v33, v6 row_newbcast:3 row_mask:0xf bank_mask:0xf
    v_and_b32_dpp v19, v33, v7 row_newbcast:3 row_mask:0xf bank_mask:0xf
    v_and_b32_dpp v20, v33, v8 row_newbcast:3 row_mask:0xf bank_mask:0xf
    v_and_b32_dpp v21, v33, v9 row_newbcast:3 row_mask:0xf bank_mask:0xf
    s_waitcnt vmcnt(15)
    s_add_u32 s67, s68, s69
    buffer_load_dwordx4 v[68:71], v1, s[36:39], s67 offen nt
    s_add_u32 s69, s69, 1024
    s_and_b32 s69, s69, 0xfc00
    v_mfma_f32_16x16x32_bf16 v[22:25], v[18:21], v[236:239], v[22:25]
    s_waitcnt vmcnt(15)
    s_add_u32 s67, s68, s69
    buffer_load_dwordx4 v[72:75], v1, s[36:39], s67 offen nt
    s_add_u32 s69, s69, 1024
    s_and_b32 s69, s69, 0xfc00
    v_and_b32_dpp v14, v34, v6 row_newbcast:3 row_mask:0xf bank_mask:0xf
    v_and_b32_dpp v15, v34, v7 row_newbcast:3 row_mask:0xf bank_mask:0xf
    v_and_b32_dpp v16, v34, v8 row_newbcast:3 row_mask:0xf bank_mask:0xf
    v_and_b32_dpp v17, v34, v9 row_newbcast:3 row_mask:0xf bank_mask:0xf
    s_waitcnt vmcnt(15)
    s_add_u32 s67, s68, s69
    buffer_load_dwordx4 v[76:79], v1, s[36:39], s67 offen nt
    s_add_u32 s69, s69, 1024
    s_and_b32 s69, s69, 0xfc00
    v_mfma_f32_16x16x32_bf16 v[22:25], v[14:17], v[240:243], v[22:25]
    s_waitcnt vmcnt(15)
    s_add_u32 s67, s68, s69
    buffer_load_dwordx4 v[80:83], v1, s[36:39], s67 offen nt
    s_add_u32 s69, s69, 1024
    s_and_b32 s69, s69, 0xfc00
    v_and_b32_dpp v18, v35, v6 row_newbcast:3 row_mask:0xf bank_mask:0xf
    v_and_b32_dpp v19, v35, v7 row_newbcast:3 row_mask:0xf bank_mask:0xf
    v_and_b32_dpp v20, v35, v8 row_newbcast:3 row_mask:0xf bank_mask:0xf
    v_and_b32_dpp v21, v35, v9 row_newbcast:3 row_mask:0xf bank_mask:0xf
    s_waitcnt vmcnt(15)
    s_add_u32 s67, s68, s69
    buffer_load_dwordx4 v[84:87], v1, s[36:39], s67 offen nt
    s_add_u32 s69, s69, 1024
    s_and_b32 s69, s69, 0xfc00
    v_mfma_f32_16x16x32_bf16 v[22:25], v[18:21], v[244:247], v[22:25]
    s_waitcnt vmcnt(15)
    s_add_u32 s67, s68, s69
    buffer_load_dwordx4 v[88:91], v1, s[36:39], s67 offen nt
    s_add_u32 s69, s69, 1024
    s_and_b32 s69, s69, 0xfc00
    v_and_b32_dpp v14, v36, v6 row_newbcast:3 row_mask:0xf bank_mask:0xf
    v_and_b32_dpp v15, v36, v7 row_newbcast:3 row_mask:0xf bank_mask:0xf
    v_and_b32_dpp v16, v36, v8 row_newbcast:3 row_mask:0xf bank_mask:0xf
    v_and_b32_dpp v17, v36, v9 row_newbcast:3 row_mask:0xf bank_mask:0xf
    s_waitcnt vmcnt(15)
    s_add_u32 s67, s68, s69
    buffer_load_dwordx4 v[92:95], v1, s[36:39], s67 offen nt
    s_add_u32 s69, s69, 1024
    s_and_b32 s69, s69, 0xfc00
    v_mfma_f32_16x16x32_bf16 v[22:25], v[14:17], v[248:251], v[22:25]
    s_waitcnt vmcnt(15)
    s_add_u32 s67, s68, s69
    buffer_load_dwordx4 v[96:99], v1, s[36:39], s67 offen nt
    s_add_u32 s69, s69, 1024
    s_and_b32 s69, s69, 0xfc00
    v_and_b32_dpp v18, v37, v6 row_newbcast:3 row_mask:0xf bank_mask:0xf
    v_and_b32_dpp v19, v37, v7 row_newbcast:3 row_mask:0xf bank_mask:0xf
    v_and_b32_dpp v20, v37, v8 row_newbcast:3 row_mask:0xf bank_mask:0xf
    v_and_b32_dpp v21, v37, v9 row_newbcast:3 row_mask:0xf bank_mask:0xf
    s_waitcnt vmcnt(14)
    s_add_u32 s67, s68, s69
    buffer_load_dwordx4 v[100:103], v1, s[36:39], s67 offen nt
    s_add_u32 s69, s69, 1024
    s_and_b32 s69, s69, 0xfc00
    s_add_u32 s67, s68, s69
    buffer_load_dwordx4 v[104:107], v1, s[36:39], s67 offen nt
    s_add_u32 s69, s69, 1024
    s_and_b32 s69, s69, 0xfc00
    s_add_u32 s67, s68, s69
    buffer_load_dwordx4 v[108:111], v1, s[36:39], s67 offen nt
    s_add_u32 s69, s69, 1024
    s_and_b32 s69, s69, 0xfc00
    s_add_u32 s67, s68, s69
    buffer_load_dwordx4 v[112:115], v1, s[36:39], s67 offen nt
    s_add_u32 s69, s69, 1024
    s_and_b32 s69, s69, 0xfc00
    s_add_u32 s67, s68, s69
    buffer_load_dwordx4 v[116:119], v1, s[36:39], s67 offen nt
    s_add_u32 s69, s69, 1024
    s_and_b32 s69, s69, 0xfc00
    v_mfma_f32_16x16x32_bf16 v[22:25], v[18:21], v[252:255], v[22:25]
    s_mov_b32 exec_hi, 0
    s_nop 6
    ds_write_b128 v38, v[22:25] offset:0
    s_mov_b32 exec_hi, -1
    s_waitcnt lgkmcnt(0)
    s_barrier
    v_and_b32 v4, 15, v0
    v_lshlrev_b32 v4, 5, v4
    ds_read_b128 v[128:131], v4 offset:0
    ds_read_b128 v[132:135], v4 offset:16
    ds_read_b128 v[136:139], v4 offset:512
    ds_read_b128 v[140:143], v4 offset:528
    ds_read_b128 v[144:147], v4 offset:1024
    ds_read_b128 v[148:151], v4 offset:1040
    ds_read_b128 v[152:155], v4 offset:1536
    ds_read_b128 v[156:159], v4 offset:1552
    s_cmp_lg_u32 s63, 0
    s_cbranch_scc1 L_noadd
    s_lshl_b32 s65, s62, 7
    v_mov_b32 v5, s65
    v_mov_b32 v22, 1
    s_mov_b64 exec, 1
    buffer_atomic_add v22, v5, s[56:59], 0 offen sc1
    s_mov_b64 exec, -1
L_noadd:
    s_waitcnt lgkmcnt(4)
    v_pk_add_f32 v[128:129], v[128:129], v[136:137]
    v_pk_add_f32 v[130:131], v[130:131], v[138:139]
    v_pk_add_f32 v[132:133], v[132:133], v[140:141]
    v_pk_add_f32 v[134:135], v[134:135], v[142:143]
    s_waitcnt lgkmcnt(0)
    v_pk_add_f32 v[144:145], v[144:145], v[152:153]
    v_pk_add_f32 v[146:147], v[146:147], v[154:155]
    v_pk_add_f32 v[148:149], v[148:149], v[156:157]
    v_pk_add_f32 v[150:151], v[150:151], v[158:159]
    v_pk_add_f32 v[128:129], v[128:129], v[144:145]
    v_pk_add_f32 v[130:131], v[130:131], v[146:147]
    v_pk_add_f32 v[132:133], v[132:133], v[148:149]
    v_pk_add_f32 v[134:135], v[134:135], v[150:151]
    v_cvt_pk_bf16_f32 v10, v128, v129
    v_cvt_pk_bf16_f32 v11, v130, v131
    v_cvt_pk_bf16_f32 v12, v132, v133
    v_cvt_pk_bf16_f32 v13, v134, v135
    s_waitcnt vmcnt(18)
    s_waitcnt vmcnt(17)
    v_dot2_f32_bf16 v30, v48, v10, 0
    v_dot2_f32_bf16 v30, v49, v11, v30
    v_dot2_f32_bf16 v30, v50, v12, v30
    v_dot2_f32_bf16 v30, v51, v13, v30
    s_waitcnt vmcnt(16)
    v_dot2_f32_bf16 v31, v52, v10, 0
    v_dot2_f32_bf16 v31, v53, v11, v31
    v_dot2_f32_bf16 v31, v54, v12, v31
    v_dot2_f32_bf16 v31, v55, v13, v31
    v_add_f32_dpp v32, v30, v30 row_ror:8 row_mask:0xf bank_mask:0x3
    s_nop 1
    v_add_f32_dpp v32, v31, v31 row_ror:8 row_mask:0xf bank_mask:0xc
    s_waitcnt vmcnt(15)
    v_dot2_f32_bf16 v30, v56, v10, 0
    v_dot2_f32_bf16 v30, v57, v11, v30
    v_dot2_f32_bf16 v30, v58, v12, v30
    v_dot2_f32_bf16 v30, v59, v13, v30
    s_waitcnt vmcnt(14)
    s_add_u32 s67, s68, s69
    buffer_load_dwordx4 v[120:123], v1, s[36:39], s67 offen nt
    s_add_u32 s69, s69, 1024
    s_and_b32 s69, s69, 0xfc00
    v_dot2_f32_bf16 v31, v60, v10, 0
    v_dot2_f32_bf16 v31, v61, v11, v31
    v_dot2_f32_bf16 v31, v62, v12, v31
    v_dot2_f32_bf16 v31, v63, v13, v31
    v_add_f32_dpp v33, v30, v30 row_ror:8 row_mask:0xf bank_mask:0x3
    s_nop 1
    v_add_f32_dpp v33, v31, v31 row_ror:8 row_mask:0xf bank_mask:0xc
    v_add_f32_dpp v34, v32, v32 row_half_mirror row_mask:0xf bank_mask:0x5
    s_nop 0
    v_add_f32_dpp v34, v33, v33 row_half_mirror row_mask:0xf bank_mask:0xa
    s_waitcnt vmcnt(14)
    s_add_u32 s67, s68, s69
    buffer_load_dwordx4 v[124:127], v1, s[36:39], s67 offen nt
    s_add_u32 s69, s69, 1024
    s_and_b32 s69, s69, 0xfc00
    v_dot2_f32_bf16 v30, v64, v10, 0
    v_dot2_f32_bf16 v30, v65, v11, v30
    v_dot2_f32_bf16 v30, v66, v12, v30
    v_dot2_f32_bf16 v30, v67, v13, v30
    s_waitcnt vmcnt(14)
    s_add_u32 s67, s68, s69
    buffer_load_dwordx4 v[48:51], v1, s[36:39], s67 offen nt
    s_add_u32 s69, s69, 1024
    s_and_b32 s69, s69, 0xfc00
    v_dot2_f32_bf16 v31, v68, v10, 0
    v_dot2_f32_bf16 v31, v69, v11, v31
    v_dot2_f32_bf16 v31, v70, v12, v31
    v_dot2_f32_bf16 v31, v71, v13, v31
    v_add_f32_dpp v32, v30, v30 row_ror:8 row_mask:0xf bank_mask:0x3
    s_nop 1
    v_add_f32_dpp v32, v31, v31 row_ror:8 row_mask:0xf bank_mask:0xc
    s_waitcnt vmcnt(14)
    s_add_u32 s67, s68, s69
    buffer_load_dwordx4 v[52:55], v1, s[36:39], s67 offen nt
    s_add_u32 s69, s69, 1024
    s_and_b32 s69, s69, 0xfc00
    v_dot2_f32_bf16 v30, v72, v10, 0
    v_dot2_f32_bf16 v30, v73, v11, v30
    v_dot2_f32_bf16 v30, v74, v12, v30
    v_dot2_f32_bf16 v30, v75, v13, v30
    s_waitcnt vmcnt(14)
    s_add_u32 s67, s68, s69
    buffer_load_dwordx4 v[56:59], v1, s[36:39], s67 offen nt
    s_add_u32 s69, s69, 1024
    s_and_b32 s69, s69, 0xfc00
    v_dot2_f32_bf16 v31, v76, v10, 0
    v_dot2_f32_bf16 v31, v77, v11, v31
    v_dot2_f32_bf16 v31, v78, v12, v31
    v_dot2_f32_bf16 v31, v79, v13, v31
    v_add_f32_dpp v33, v30, v30 row_ror:8 row_mask:0xf bank_mask:0x3
    s_nop 1
    v_add_f32_dpp v33, v31, v31 row_ror:8 row_mask:0xf bank_mask:0xc
    v_add_f32_dpp v35, v32, v32 row_half_mirror row_mask:0xf bank_mask:0x5
    s_nop 0
    v_add_f32_dpp v35, v33, v33 row_half_mirror row_mask:0xf bank_mask:0xa
    v_add_f32_dpp v4, v34, v34 quad_perm:[2,3,0,1] row_mask:0xf bank_mask:0xf
    s_nop 0
    v_add_f32_dpp v5, v35, v35 quad_perm:[2,3,0,1] row_mask:0xf bank_mask:0xf
    v_cndmask_b32 v36, v4, v5, s[78:79]
    s_waitcnt vmcnt(14)
    s_add_u32 s67, s68, s69
    buffer_load_dwordx4 v[60:63], v1, s[36:39], s67 offen nt
    s_add_u32 s69, s69, 1024
    s_and_b32 s69, s69, 0xfc00
    v_dot2_f32_bf16 v30, v80, v10, 0
    v_dot2_f32_bf16 v30, v81, v11, v30
    v_dot2_f32_bf16 v30, v82, v12, v30
    v_dot2_f32_bf16 v30, v83, v13, v30
    s_waitcnt vmcnt(14)
    s_add_u32 s67, s68, s69
    buffer_load_dwordx4 v[64:67], v1, s[36:39], s67 offen nt
    s_add_u32 s69, s69, 1024
    s_and_b32 s69, s69, 0xfc00
    v_dot2_f32_bf16 v31, v84, v10, 0
    v_dot2_f32_bf16 v31, v85, v11, v31
    v_dot2_f32_bf16 v31, v86, v12, v31
    v_dot2_f32_bf16 v31, v87, v13, v31
    v_add_f32_dpp v32, v30, v30 row_ror:8 row_mask:0xf bank_mask:0x3
    s_nop 1
    v_add_f32_dpp v32, v31, v31 row_ror:8 row_mask:0xf bank_mask:0xc
    s_waitcnt vmcnt(14)
    s_add_u32 s67, s68, s69
    buffer_load_dwordx4 v[68:71], v1, s[36:39], s67 offen nt
    s_add_u32 s69, s69, 1024
    s_and_b32 s69, s69, 0xfc00
    v_dot2_f32_bf16 v30, v88, v10, 0
    v_dot2_f32_bf16 v30, v89, v11, v30
    v_dot2_f32_bf16 v30, v90, v12, v30
    v_dot2_f32_bf16 v30, v91, v13, v30
    s_waitcnt vmcnt(14)
    s_add_u32 s67, s68, s69
    buffer_load_dwordx4 v[72:75], v1, s[36:39], s67 offen nt
    s_add_u32 s69, s69, 1024
    s_and_b32 s69, s69, 0xfc00
    v_dot2_f32_bf16 v31, v92, v10, 0
    v_dot2_f32_bf16 v31, v93, v11, v31
    v_dot2_f32_bf16 v31, v94, v12, v31
    v_dot2_f32_bf16 v31, v95, v13, v31
    v_add_f32_dpp v33, v30, v30 row_ror:8 row_mask:0xf bank_mask:0x3
    s_nop 1
    v_add_f32_dpp v33, v31, v31 row_ror:8 row_mask:0xf bank_mask:0xc
    v_add_f32_dpp v34, v32, v32 row_half_mirror row_mask:0xf bank_mask:0x5
    s_nop 0
    v_add_f32_dpp v34, v33, v33 row_half_mirror row_mask:0xf bank_mask:0xa
    s_waitcnt vmcnt(14)
    s_add_u32 s67, s68, s69
    buffer_load_dwordx4 v[76:79], v1, s[36:39], s67 offen nt
    s_add_u32 s69, s69, 1024
    s_and_b32 s69, s69, 0xfc00
    v_dot2_f32_bf16 v30, v96, v10, 0
    v_dot2_f32_bf16 v30, v97, v11, v30
    v_dot2_f32_bf16 v30, v98, v12, v30
    v_dot2_f32_bf16 v30, v99, v13, v30
    s_waitcnt vmcnt(14)
    s_add_u32 s67, s68, s69
    buffer_load_dwordx4 v[80:83], v1, s[36:39], s67 offen nt
    s_add_u32 s69, s69, 1024
    s_and_b32 s69, s69, 0xfc00
    v_dot2_f32_bf16 v31, v100, v10, 0
    v_dot2_f32_bf16 v31, v101, v11, v31
    v_dot2_f32_bf16 v31, v102, v12, v31
    v_dot2_f32_bf16 v31, v103, v13, v31
    v_add_f32_dpp v32, v30, v30 row_ror:8 row_mask:0xf bank_mask:0x3
    s_nop 1
    v_add_f32_dpp v32, v31, v31 row_ror:8 row_mask:0xf bank_mask:0xc
    s_waitcnt vmcnt(14)
    s_add_u32 s67, s68, s69
    buffer_load_dwordx4 v[84:87], v1, s[36:39], s67 offen nt
    s_add_u32 s69, s69, 1024
    s_and_b32 s69, s69, 0xfc00
    v_dot2_f32_bf16 v30, v104, v10, 0
    v_dot2_f32_bf16 v30, v105, v11, v30
    v_dot2_f32_bf16 v30, v106, v12, v30
    v_dot2_f32_bf16 v30, v107, v13, v30
    s_waitcnt vmcnt(14)
    s_add_u32 s67, s68, s69
    buffer_load_dwordx4 v[88:91], v1, s[36:39], s67 offen nt
    s_add_u32 s69, s69, 1024
    s_and_b32 s69, s69, 0xfc00
    v_dot2_f32_bf16 v31, v108, v10, 0
    v_dot2_f32_bf16 v31, v109, v11, v31
    v_dot2_f32_bf16 v31, v110, v12, v31
    v_dot2_f32_bf16 v31, v111, v13, v31
    v_add_f32_dpp v33, v30, v30 row_ror:8 row_mask:0xf bank_mask:0x3
    s_nop 1
    v_add_f32_dpp v33, v31, v31 row_ror:8 row_mask:0xf bank_mask:0xc
    v_add_f32_dpp v35, v32, v32 row_half_mirror row_mask:0xf bank_mask:0x5
    s_nop 0
    v_add_f32_dpp v35, v33, v33 row_half_mirror row_mask:0xf bank_mask:0xa
    v_add_f32_dpp v4, v34, v34 quad_perm:[2,3,0,1] row_mask:0xf bank_mask:0xf
    s_nop 0
    v_add_f32_dpp v5, v35, v35 quad_perm:[2,3,0,1] row_mask:0xf bank_mask:0xf
    v_cndmask_b32 v37, v4, v5, s[78:79]
    v_add_f32_dpp v4, v36, v36 quad_perm:[1,0,3,2] row_mask:0xf bank_mask:0xf
    s_nop 0
    v_add_f32_dpp v5, v37, v37 quad_perm:[1,0,3,2] row_mask:0xf bank_mask:0xf
    v_cndmask_b32 v26, v4, v5, s[80:81]
    v_cvt_pk_bf16_f32 v26, v26, v26
    v_and_b32 v26, 0xffff0000, v26
    v_mul_f32 v26, 0x3db504f3, v26
    v_cvt_pk_bf16_f32 v26, v26, v26
    v_and_b32 v26, 0xffff0000, v26
    s_waitcnt vmcnt(14)
    s_add_u32 s67, s68, s69
    buffer_load_dwordx4 v[92:95], v1, s[36:39], s67 offen nt
    s_add_u32 s69, s69, 1024
    s_and_b32 s69, s69, 0xfc00
    v_dot2_f32_bf16 v30, v112, v10, 0
    v_dot2_f32_bf16 v30, v113, v11, v30
    v_dot2_f32_bf16 v30, v114, v12, v30
    v_dot2_f32_bf16 v30, v115, v13, v30
    s_waitcnt vmcnt(14)
    buffer_load_dwordx4 v[96:99], v3, s[48:51], s72 offen offset:0 nt
    v_dot2_f32_bf16 v31, v116, v10, 0
    v_dot2_f32_bf16 v31, v117, v11, v31
    v_dot2_f32_bf16 v31, v118, v12, v31
    v_dot2_f32_bf16 v31, v119, v13, v31
    v_add_f32_dpp v32, v30, v30 row_ror:8 row_mask:0xf bank_mask:0x3
    s_nop 1
    v_add_f32_dpp v32, v31, v31 row_ror:8 row_mask:0xf bank_mask:0xc
    s_waitcnt vmcnt(14)
    s_add_u32 s67, s68, s69
    buffer_load_dwordx4 v[100:103], v1, s[36:39], s67 offen nt
    s_add_u32 s69, s69, 1024
    s_and_b32 s69, s69, 0xfc00
    v_dot2_f32_bf16 v30, v120, v10, 0
    v_dot2_f32_bf16 v30, v121, v11, v30
    v_dot2_f32_bf16 v30, v122, v12, v30
    v_dot2_f32_bf16 v30, v123, v13, v30
    s_waitcnt vmcnt(14)
    buffer_load_dwordx4 v[104:107], v3, s[48:51], s72 offen offset:1024 nt
    v_dot2_f32_bf16 v31, v124, v10, 0
    v_dot2_f32_bf16 v31, v125, v11, v31
    v_dot2_f32_bf16 v31, v126, v12, v31
    v_dot2_f32_bf16 v31, v127, v13, v31
    v_add_f32_dpp v33, v30, v30 row_ror:8 row_mask:0xf bank_mask:0x3
    s_nop 1
    v_add_f32_dpp v33, v31, v31 row_ror:8 row_mask:0xf bank_mask:0xc
    v_add_f32_dpp v34, v32, v32 row_half_mirror row_mask:0xf bank_mask:0x5
    s_nop 0
    v_add_f32_dpp v34, v33, v33 row_half_mirror row_mask:0xf bank_mask:0xa
    s_waitcnt vmcnt(14)
    s_add_u32 s67, s68, s69
    buffer_load_dwordx4 v[108:111], v1, s[36:39], s67 offen nt
    s_add_u32 s69, s69, 1024
    s_and_b32 s69, s69, 0xfc00
    v_dot2_f32_bf16 v30, v48, v10, 0
    v_dot2_f32_bf16 v30, v49, v11, v30
    v_dot2_f32_bf16 v30, v50, v12, v30
    v_dot2_f32_bf16 v30, v51, v13, v30
    s_waitcnt vmcnt(14)
    buffer_load_dwordx4 v[112:115], v3, s[48:51], s72 offen offset:2048 nt
    v_dot2_f32_bf16 v31, v52, v10, 0
    v_dot2_f32_bf16 v31, v53, v11, v31
    v_dot2_f32_bf16 v31, v54, v12, v31
    v_dot2_f32_bf16 v31, v55, v13, v31
    v_add_f32_dpp v32, v30, v30 row_ror:8 row_mask:0xf bank_mask:0x3
    s_nop 1
    v_add_f32_dpp v32, v31, v31 row_ror:8 row_mask:0xf bank_mask:0xc
    s_waitcnt vmcnt(14)
    s_add_u32 s67, s68, s69
    buffer_load_dwordx4 v[116:119], v1, s[36:39], s67 offen nt
    s_add_u32 s69, s69, 1024
    s_and_b32 s69, s69, 0xfc00
    v_dot2_f32_bf16 v30, v56, v10, 0
    v_dot2_f32_bf16 v30, v57, v11, v30
    v_dot2_f32_bf16 v30, v58, v12, v30
    v_dot2_f32_bf16 v30, v59, v13, v30
    s_waitcnt vmcnt(14)
    buffer_load_dwordx4 v[120:123], v3, s[48:51], s72 offen offset:3072 nt
    s_add_u32 s72, s72, 4096
    v_dot2_f32_bf16 v31, v60, v10, 0
    v_dot2_f32_bf16 v31, v61, v11, v31
    v_dot2_f32_bf16 v31, v62, v12, v31
    v_dot2_f32_bf16 v31, v63, v13, v31
    v_add_f32_dpp v33, v30, v30 row_ror:8 row_mask:0xf bank_mask:0x3
    s_nop 1
    v_add_f32_dpp v33, v31, v31 row_ror:8 row_mask:0xf bank_mask:0xc
    v_add_f32_dpp v35, v32, v32 row_half_mirror row_mask:0xf bank_mask:0x5
    s_nop 0
    v_add_f32_dpp v35, v33, v33 row_half_mirror row_mask:0xf bank_mask:0xa
    v_add_f32_dpp v4, v34, v34 quad_perm:[2,3,0,1] row_mask:0xf bank_mask:0xf
    s_nop 0
    v_add_f32_dpp v5, v35, v35 quad_perm:[2,3,0,1] row_mask:0xf bank_mask:0xf
    v_cndmask_b32 v36, v4, v5, s[78:79]
    s_waitcnt vmcnt(14)
    s_add_u32 s67, s68, s69
    buffer_load_dwordx4 v[124:127], v1, s[36:39], s67 offen nt
    s_add_u32 s69, s69, 1024
    s_and_b32 s69, s69, 0xfc00
    v_dot2_f32_bf16 v30, v64, v10, 0
    v_dot2_f32_bf16 v30, v65, v11, v30
    v_dot2_f32_bf16 v30, v66, v12, v30
    v_dot2_f32_bf16 v30, v67, v13, v30
    s_waitcnt vmcnt(14)
    buffer_load_dwordx4 v[48:51], v3, s[48:51], s72 offen offset:0 nt
    v_dot2_f32_bf16 v31, v68, v10, 0
    v_dot2_f32_bf16 v31, v69, v11, v31
    v_dot2_f32_bf16 v31, v70, v12, v31
    v_dot2_f32_bf16 v31, v71, v13, v31
    v_add_f32_dpp v32, v30, v30 row_ror:8 row_mask:0xf bank_mask:0x3
    s_nop 1
    v_add_f32_dpp v32, v31, v31 row_ror:8 row_mask:0xf bank_mask:0xc
    s_waitcnt vmcnt(14)
    s_add_u32 s67, s68, s69
    buffer_load_dwordx4 v[52:55], v1, s[36:39], s67 offen nt
    s_add_u32 s69, s69, 1024
    s_and_b32 s69, s69, 0xfc00
    v_dot2_f32_bf16 v30, v72, v10, 0
    v_dot2_f32_bf16 v30, v73, v11, v30
    v_dot2_f32_bf16 v30, v74, v12, v30
    v_dot2_f32_bf16 v30, v75, v13, v30
    s_waitcnt vmcnt(14)
    buffer_load_dwordx4 v[56:59], v3, s[48:51], s72 offen offset:1024 nt
    v_dot2_f32_bf16 v31, v76, v10, 0
    v_dot2_f32_bf16 v31, v77, v11, v31
    v_dot2_f32_bf16 v31, v78, v12, v31
    v_dot2_f32_bf16 v31, v79, v13, v31
    v_add_f32_dpp v33, v30, v30 row_ror:8 row_mask:0xf bank_mask:0x3
    s_nop 1
    v_add_f32_dpp v33, v31, v31 row_ror:8 row_mask:0xf bank_mask:0xc
    v_add_f32_dpp v34, v32, v32 row_half_mirror row_mask:0xf bank_mask:0x5
    s_nop 0
    v_add_f32_dpp v34, v33, v33 row_half_mirror row_mask:0xf bank_mask:0xa
    s_waitcnt vmcnt(14)
    s_add_u32 s67, s68, s69
    buffer_load_dwordx4 v[60:63], v1, s[36:39], s67 offen nt
    s_add_u32 s69, s69, 1024
    s_and_b32 s69, s69, 0xfc00
    v_dot2_f32_bf16 v30, v80, v10, 0
    v_dot2_f32_bf16 v30, v81, v11, v30
    v_dot2_f32_bf16 v30, v82, v12, v30
    v_dot2_f32_bf16 v30, v83, v13, v30
    s_waitcnt vmcnt(14)
    buffer_load_dwordx4 v[64:67], v3, s[48:51], s72 offen offset:2048 nt
    v_dot2_f32_bf16 v31, v84, v10, 0
    v_dot2_f32_bf16 v31, v85, v11, v31
    v_dot2_f32_bf16 v31, v86, v12, v31
    v_dot2_f32_bf16 v31, v87, v13, v31
    v_add_f32_dpp v32, v30, v30 row_ror:8 row_mask:0xf bank_mask:0x3
    s_nop 1
    v_add_f32_dpp v32, v31, v31 row_ror:8 row_mask:0xf bank_mask:0xc
    s_waitcnt vmcnt(14)
    s_add_u32 s67, s68, s69
    buffer_load_dwordx4 v[68:71], v1, s[36:39], s67 offen nt
    s_add_u32 s69, s69, 1024
    s_and_b32 s69, s69, 0xfc00
    v_dot2_f32_bf16 v30, v88, v10, 0
    v_dot2_f32_bf16 v30, v89, v11, v30
    v_dot2_f32_bf16 v30, v90, v12, v30
    v_dot2_f32_bf16 v30, v91, v13, v30
    s_waitcnt vmcnt(14)
    buffer_load_dwordx4 v[72:75], v3, s[48:51], s72 offen offset:3072 nt
    s_add_u32 s72, s72, 28672
    v_dot2_f32_bf16 v31, v92, v10, 0
    v_dot2_f32_bf16 v31, v93, v11, v31
    v_dot2_f32_bf16 v31, v94, v12, v31
    v_dot2_f32_bf16 v31, v95, v13, v31
    v_add_f32_dpp v33, v30, v30 row_ror:8 row_mask:0xf bank_mask:0x3
    s_nop 1
    v_add_f32_dpp v33, v31, v31 row_ror:8 row_mask:0xf bank_mask:0xc
    v_add_f32_dpp v35, v32, v32 row_half_mirror row_mask:0xf bank_mask:0x5
    s_nop 0
    v_add_f32_dpp v35, v33, v33 row_half_mirror row_mask:0xf bank_mask:0xa
    v_add_f32_dpp v4, v34, v34 quad_perm:[2,3,0,1] row_mask:0xf bank_mask:0xf
    s_nop 0
    v_add_f32_dpp v5, v35, v35 quad_perm:[2,3,0,1] row_mask:0xf bank_mask:0xf
    v_cndmask_b32 v37, v4, v5, s[78:79]
    v_add_f32_dpp v4, v36, v36 quad_perm:[1,0,3,2] row_mask:0xf bank_mask:0xf
    s_nop 0
    v_add_f32_dpp v5, v37, v37 quad_perm:[1,0,3,2] row_mask:0xf bank_mask:0xf
    v_cndmask_b32 v27, v4, v5, s[80:81]
    v_cvt_pk_bf16_f32 v27, v27, v27
    v_and_b32 v27, 0xffff0000, v27
    v_mul_f32 v27, 0x3db504f3, v27
    v_cvt_pk_bf16_f32 v27, v27, v27
    v_and_b32 v27, 0xffff0000, v27
    s_waitcnt vmcnt(14)
    s_add_u32 s67, s68, s69
    buffer_load_dwordx4 v[76:79], v1, s[36:39], s67 offen nt
    s_add_u32 s69, s69, 1024
    s_and_b32 s69, s69, 0xfc00
    s_waitcnt vmcnt(14)
    buffer_load_dwordx4 v[80:83], v3, s[48:51], s72 offen offset:0 nt
    v_dot2_f32_bf16 v30, v100, v10, 0
    v_dot2_f32_bf16 v30, v101, v11, v30
    v_dot2_f32_bf16 v30, v102, v12, v30
    v_dot2_f32_bf16 v30, v103, v13, v30
    s_waitcnt vmcnt(14)
    s_add_u32 s67, s68, s69
    buffer_load_dwordx4 v[84:87], v1, s[36:39], s67 offen nt
    s_add_u32 s69, s69, 1024
    s_and_b32 s69, s69, 0xfc00
    v_perm_b32 v128, v104, v96, s73
    v_perm_b32 v132, v104, v96, s74
    v_perm_b32 v136, v105, v97, s73
    v_perm_b32 v140, v105, v97, s74
    v_perm_b32 v144, v106, v98, s73
    v_perm_b32 v148, v106, v98, s74
    v_perm_b32 v152, v107, v99, s73
    v_perm_b32 v156, v107, v99, s74
    s_waitcnt vmcnt(14)
    buffer_load_dwordx4 v[88:91], v3, s[48:51], s72 offen offset:1024 nt
    v_dot2_f32_bf16 v31, v108, v10, 0
    v_dot2_f32_bf16 v31, v109, v11, v31
    v_dot2_f32_bf16 v31, v110, v12, v31
    v_dot2_f32_bf16 v31, v111, v13, v31
    v_add_f32_dpp v32, v30, v30 row_ror:8 row_mask:0xf bank_mask:0x3
    s_nop 1
    v_add_f32_dpp v32, v31, v31 row_ror:8 row_mask:0xf bank_mask:0xc
    s_waitcnt vmcnt(14)
    s_add_u32 s67, s68, s69
    buffer_load_dwordx4 v[92:95], v1, s[36:39], s67 offen nt
    s_add_u32 s69, s69, 1024
    s_and_b32 s69, s69, 0xfc00
    s_waitcnt vmcnt(14)
    buffer_load_dwordx4 v[100:103], v3, s[48:51], s72 offen offset:2048 nt
    v_dot2_f32_bf16 v30, v116, v10, 0
    v_dot2_f32_bf16 v30, v117, v11, v30
    v_dot2_f32_bf16 v30, v118, v12, v30
    v_dot2_f32_bf16 v30, v119, v13, v30
    s_waitcnt vmcnt(14)
    s_add_u32 s67, s68, s69
    buffer_load_dwordx4 v[96:99], v1, s[36:39], s67 offen nt
    s_add_u32 s69, s69, 1024
    s_and_b32 s69, s69, 0xfc00
    v_perm_b32 v129, v120, v112, s73
    v_perm_b32 v133, v120, v112, s74
    v_perm_b32 v137, v121, v113, s73
    v_perm_b32 v141, v121, v113, s74
    v_perm_b32 v145, v122, v114, s73
    v_perm_b32 v149, v122, v114, s74
    v_perm_b32 v153, v123, v115, s73
    v_perm_b32 v157, v123, v115, s74
    s_waitcnt vmcnt(14)
    buffer_load_dwordx4 v[104:107], v3, s[48:51], s72 offen offset:3072 nt
    s_add_u32 s72, s72, 4096
    v_dot2_f32_bf16 v31, v124, v10, 0
    v_dot2_f32_bf16 v31, v125, v11, v31
    v_dot2_f32_bf16 v31, v126, v12, v31
    v_dot2_f32_bf16 v31, v127, v13, v31
    v_add_f32_dpp v33, v30, v30 row_ror:8 row_mask:0xf bank_mask:0x3
    s_nop 1
    v_add_f32_dpp v33, v31, v31 row_ror:8 row_mask:0xf bank_mask:0xc
    v_add_f32_dpp v34, v32, v32 row_half_mirror row_mask:0xf bank_mask:0x5
    s_nop 0
    v_add_f32_dpp v34, v33, v33 row_half_mirror row_mask:0xf bank_mask:0xa
    s_waitcnt vmcnt(14)
    s_add_u32 s67, s68, s69
    buffer_load_dwordx4 v[108:111], v1, s[36:39], s67 offen nt
    s_add_u32 s69, s69, 1024
    s_and_b32 s69, s69, 0xfc00
    s_waitcnt vmcnt(14)
    buffer_load_dwordx4 v[116:119], v3, s[48:51], s72 offen offset:0 nt
    v_dot2_f32_bf16 v30, v52, v10, 0
    v_dot2_f32_bf16 v30, v53, v11, v30
    v_dot2_f32_bf16 v30, v54, v12, v30
    v_dot2_f32_bf16 v30, v55, v13, v30
    s_waitcnt vmcnt(14)
    s_add_u32 s67, s68, s69
    buffer_load_dwordx4 v[112:115], v1, s[36:39], s67 offen nt
    s_add_u32 s69, s69, 1024
    s_and_b32 s69, s69, 0xfc00
    v_perm_b32 v130, v56, v48, s73
    v_perm_b32 v134, v56, v48, s74
    v_perm_b32 v138, v57, v49, s73
    v_perm_b32 v142, v57, v49, s74
    v_perm_b32 v146, v58, v50, s73
    v_perm_b32 v150, v58, v50, s74
    v_perm_b32 v154, v59, v51, s73
    v_perm_b32 v158, v59, v51, s74
    s_waitcnt vmcnt(14)
    buffer_load_dwordx4 v[120:123], v3, s[48:51], s72 offen offset:1024 nt
    v_dot2_f32_bf16 v31, v60, v10, 0
    v_dot2_f32_bf16 v31, v61, v11, v31
    v_dot2_f32_bf16 v31, v62, v12, v31
    v_dot2_f32_bf16 v31, v63, v13, v31
    v_add_f32_dpp v32, v30, v30 row_ror:8 row_mask:0xf bank_mask:0x3
    s_nop 1
    v_add_f32_dpp v32, v31, v31 row_ror:8 row_mask:0xf bank_mask:0xc
    s_waitcnt vmcnt(14)
    s_add_u32 s67, s68, s69
    buffer_load_dwordx4 v[124:127], v1, s[36:39], s67 offen nt
    s_add_u32 s69, s69, 1024
    s_and_b32 s69, s69, 0xfc00
    s_waitcnt vmcnt(14)
    buffer_load_dwordx4 v[52:55], v3, s[48:51], s72 offen offset:2048 nt
    v_dot2_f32_bf16 v30, v68, v10, 0
    v_dot2_f32_bf16 v30, v69, v11, v30
    v_dot2_f32_bf16 v30, v70, v12, v30
    v_dot2_f32_bf16 v30, v71, v13, v30
    s_waitcnt vmcnt(14)
    s_add_u32 s67, s68, s69
    buffer_load_dwordx4 v[48:51], v1, s[36:39], s67 offen nt
    s_add_u32 s69, s69, 1024
    s_and_b32 s69, s69, 0xfc00
    v_perm_b32 v131, v72, v64, s73
    v_perm_b32 v135, v72, v64, s74
    v_perm_b32 v139, v73, v65, s73
    v_perm_b32 v143, v73, v65, s74
    v_perm_b32 v147, v74, v66, s73
    v_perm_b32 v151, v74, v66, s74
    v_perm_b32 v155, v75, v67, s73
    v_perm_b32 v159, v75, v67, s74
    s_waitcnt vmcnt(14)
    buffer_load_dwordx4 v[56:59], v3, s[48:51], s72 offen offset:3072 nt
    s_add_u32 s72, s72, 28672
    v_dot2_f32_bf16 v31, v76, v10, 0
    v_dot2_f32_bf16 v31, v77, v11, v31
    v_dot2_f32_bf16 v31, v78, v12, v31
    v_dot2_f32_bf16 v31, v79, v13, v31
    v_add_f32_dpp v33, v30, v30 row_ror:8 row_mask:0xf bank_mask:0x3
    s_nop 1
    v_add_f32_dpp v33, v31, v31 row_ror:8 row_mask:0xf bank_mask:0xc
    v_add_f32_dpp v35, v32, v32 row_half_mirror row_mask:0xf bank_mask:0x5
    s_nop 0
    v_add_f32_dpp v35, v33, v33 row_half_mirror row_mask:0xf bank_mask:0xa
    v_add_f32_dpp v4, v34, v34 quad_perm:[2,3,0,1] row_mask:0xf bank_mask:0xf
    s_nop 0
    v_add_f32_dpp v5, v35, v35 quad_perm:[2,3,0,1] row_mask:0xf bank_mask:0xf
    v_cndmask_b32 v36, v4, v5, s[78:79]
    s_waitcnt vmcnt(14)
    s_add_u32 s67, s68, s69
    buffer_load_dwordx4 v[60:63], v1, s[36:39], s67 offen nt
    s_add_u32 s69, s69, 1024
    s_and_b32 s69, s69, 0xfc00
    s_waitcnt vmcnt(14)
    buffer_load_dwordx4 v[68:71], v3, s[48:51], s72 offen offset:0 nt
    v_dot2_f32_bf16 v30, v84, v10, 0
    v_dot2_f32_bf16 v30, v85, v11, v30
    v_dot2_f32_bf16 v30, v86, v12, v30
    v_dot2_f32_bf16 v30, v87, v13, v30
    s_waitcnt vmcnt(14)
    s_add_u32 s67, s68, s69
    buffer_load_dwordx4 v[64:67], v1, s[36:39], s67 offen nt
    s_add_u32 s69, s69, 1024
    s_and_b32 s69, s69, 0xfc00
    v_perm_b32 v160, v88, v80, s73
    v_perm_b32 v164, v88, v80, s74
    v_perm_b32 v168, v89, v81, s73
    v_perm_b32 v172, v89, v81, s74
    v_perm_b32 v176, v90, v82, s73
    v_perm_b32 v180, v90, v82, s74
    v_perm_b32 v184, v91, v83, s73
    v_perm_b32 v188, v91, v83, s74
    s_waitcnt vmcnt(14)
    buffer_load_dwordx4 v[72:75], v3, s[48:51], s72 offen offset:1024 nt
    v_dot2_f32_bf16 v31, v92, v10, 0
    v_dot2_f32_bf16 v31, v93, v11, v31
    v_dot2_f32_bf16 v31, v94, v12, v31
    v_dot2_f32_bf16 v31, v95, v13, v31
    v_add_f32_dpp v32, v30, v30 row_ror:8 row_mask:0xf bank_mask:0x3
    s_nop 1
    v_add_f32_dpp v32, v31, v31 row_ror:8 row_mask:0xf bank_mask:0xc
    s_waitcnt vmcnt(14)
    s_add_u32 s67, s68, s69
    buffer_load_dwordx4 v[76:79], v1, s[36:39], s67 offen nt
    s_add_u32 s69, s69, 1024
    s_and_b32 s69, s69, 0xfc00
    s_waitcnt vmcnt(14)
    buffer_load_dwordx4 v[84:87], v3, s[48:51], s72 offen offset:2048 nt
    v_dot2_f32_bf16 v30, v96, v10, 0
    v_dot2_f32_bf16 v30, v97, v11, v30
    v_dot2_f32_bf16 v30, v98, v12, v30
    v_dot2_f32_bf16 v30, v99, v13, v30
    s_waitcnt vmcnt(14)
    s_add_u32 s67, s68, s69
    buffer_load_dwordx4 v[80:83], v1, s[36:39], s67 offen nt
    s_add_u32 s69, s69, 1024
    s_and_b32 s69, s69, 0xfc00
    v_perm_b32 v161, v104, v100, s73
    v_perm_b32 v165, v104, v100, s74
    v_perm_b32 v169, v105, v101, s73
    v_perm_b32 v173, v105, v101, s74
    v_perm_b32 v177, v106, v102, s73
    v_perm_b32 v181, v106, v102, s74
    v_perm_b32 v185, v107, v103, s73
    v_perm_b32 v189, v107, v103, s74
    s_waitcnt vmcnt(14)
    buffer_load_dwordx4 v[88:91], v3, s[48:51], s72 offen offset:3072 nt
    s_add_u32 s72, s72, 4096
    v_dot2_f32_bf16 v31, v108, v10, 0
    v_dot2_f32_bf16 v31, v109, v11, v31
    v_dot2_f32_bf16 v31, v110, v12, v31
    v_dot2_f32_bf16 v31, v111, v13, v31
    v_add_f32_dpp v33, v30, v30 row_ror:8 row_mask:0xf bank_mask:0x3
    s_nop 1
    v_add_f32_dpp v33, v31, v31 row_ror:8 row_mask:0xf bank_mask:0xc
    v_add_f32_dpp v34, v32, v32 row_half_mirror row_mask:0xf bank_mask:0x5
    s_nop 0
    v_add_f32_dpp v34, v33, v33 row_half_mirror row_mask:0xf bank_mask:0xa
    s_waitcnt vmcnt(14)
    s_add_u32 s67, s68, s69
    buffer_load_dwordx4 v[92:95], v1, s[36:39], s67 offen nt
    s_add_u32 s69, s69, 1024
    s_and_b32 s69, s69, 0xfc00
    s_waitcnt vmcnt(14)
    buffer_load_dwordx4 v[96:99], v3, s[48:51], s72 offen offset:0 nt
    v_dot2_f32_bf16 v30, v112, v10, 0
    v_dot2_f32_bf16 v30, v113, v11, v30
    v_dot2_f32_bf16 v30, v114, v12, v30
    v_dot2_f32_bf16 v30, v115, v13, v30
    s_waitcnt vmcnt(14)
    s_add_u32 s67, s68, s69
    buffer_load_dwordx4 v[100:103], v1, s[36:39], s67 offen nt
    s_add_u32 s69, s69, 1024
    s_and_b32 s69, s69, 0xfc00
    v_perm_b32 v162, v120, v116, s73
    v_perm_b32 v166, v120, v116, s74
    v_perm_b32 v170, v121, v117, s73
    v_perm_b32 v174, v121, v117, s74
    v_perm_b32 v178, v122, v118, s73
    v_perm_b32 v182, v122, v118, s74
    v_perm_b32 v186, v123, v119, s73
    v_perm_b32 v190, v123, v119, s74
    s_waitcnt vmcnt(14)
    buffer_load_dwordx4 v[104:107], v3, s[48:51], s72 offen offset:1024 nt
    v_dot2_f32_bf16 v31, v124, v10, 0
    v_dot2_f32_bf16 v31, v125, v11, v31
    v_dot2_f32_bf16 v31, v126, v12, v31
    v_dot2_f32_bf16 v31, v127, v13, v31
    v_add_f32_dpp v32, v30, v30 row_ror:8 row_mask:0xf bank_mask:0x3
    s_nop 1
    v_add_f32_dpp v32, v31, v31 row_ror:8 row_mask:0xf bank_mask:0xc
    s_waitcnt vmcnt(14)
    s_add_u32 s67, s68, s69
    buffer_load_dwordx4 v[108:111], v1, s[36:39], s67 offen nt
    s_add_u32 s69, s69, 1024
    s_and_b32 s69, s69, 0xfc00
    s_waitcnt vmcnt(14)
    buffer_load_dwordx4 v[112:115], v3, s[48:51], s72 offen offset:2048 nt
    v_dot2_f32_bf16 v30, v48, v10, 0
    v_dot2_f32_bf16 v30, v49, v11, v30
    v_dot2_f32_bf16 v30, v50, v12, v30
    v_dot2_f32_bf16 v30, v51, v13, v30
    s_waitcnt vmcnt(14)
    s_add_u32 s67, s68, s69
    buffer_load_dwordx4 v[116:119], v1, s[36:39], s67 offen nt
    s_add_u32 s69, s69, 1024
    s_and_b32 s69, s69, 0xfc00
    v_perm_b32 v163, v56, v52, s73
    v_perm_b32 v167, v56, v52, s74
    v_perm_b32 v171, v57, v53, s73
    v_perm_b32 v175, v57, v53, s74
    v_perm_b32 v179, v58, v54, s73
    v_perm_b32 v183, v58, v54, s74
    v_perm_b32 v187, v59, v55, s73
    v_perm_b32 v191, v59, v55, s74
    s_waitcnt vmcnt(14)
    buffer_load_dwordx4 v[120:123], v3, s[48:51], s72 offen offset:3072 nt
    s_add_u32 s72, s72, 28672
    v_dot2_f32_bf16 v31, v60, v10, 0
    v_dot2_f32_bf16 v31, v61, v11, v31
    v_dot2_f32_bf16 v31, v62, v12, v31
    v_dot2_f32_bf16 v31, v63, v13, v31
    v_add_f32_dpp v33, v30, v30 row_ror:8 row_mask:0xf bank_mask:0x3
    s_nop 1
    v_add_f32_dpp v33, v31, v31 row_ror:8 row_mask:0xf bank_mask:0xc
    v_add_f32_dpp v35, v32, v32 row_half_mirror row_mask:0xf bank_mask:0x5
    s_nop 0
    v_add_f32_dpp v35, v33, v33 row_half_mirror row_mask:0xf bank_mask:0xa
    v_add_f32_dpp v4, v34, v34 quad_perm:[2,3,0,1] row_mask:0xf bank_mask:0xf
    s_nop 0
    v_add_f32_dpp v5, v35, v35 quad_perm:[2,3,0,1] row_mask:0xf bank_mask:0xf
    v_cndmask_b32 v37, v4, v5, s[78:79]
    v_add_f32_dpp v4, v36, v36 quad_perm:[1,0,3,2] row_mask:0xf bank_mask:0xf
    s_nop 0
    v_add_f32_dpp v5, v37, v37 quad_perm:[1,0,3,2] row_mask:0xf bank_mask:0xf
    v_cndmask_b32 v28, v4, v5, s[80:81]
    v_cvt_pk_bf16_f32 v28, v28, v28
    v_and_b32 v28, 0xffff0000, v28
    v_mul_f32 v28, 0x3db504f3, v28
    v_cvt_pk_bf16_f32 v28, v28, v28
    v_and_b32 v28, 0xffff0000, v28
    s_waitcnt vmcnt(14)
    s_add_u32 s67, s68, s69
    buffer_load_dwordx4 v[124:127], v1, s[36:39], s67 offen nt
    s_add_u32 s69, s69, 1024
    s_and_b32 s69, s69, 0xfc00
    s_waitcnt vmcnt(14)
    buffer_load_dwordx4 v[48:51], v3, s[48:51], s72 offen offset:0 nt
    v_dot2_f32_bf16 v30, v64, v10, 0
    v_dot2_f32_bf16 v30, v65, v11, v30
    v_dot2_f32_bf16 v30, v66, v12, v30
    v_dot2_f32_bf16 v30, v67, v13, v30
    s_waitcnt vmcnt(14)
    s_add_u32 s67, s68, s69
    buffer_load_dwordx4 v[52:55], v1, s[36:39], s67 offen nt
    s_add_u32 s69, s69, 1024
    s_and_b32 s69, s69, 0xfc00
    v_perm_b32 v192, v72, v68, s73
    v_perm_b32 v196, v72, v68, s74
    v_perm_b32 v200, v73, v69, s73
    v_perm_b32 v204, v73, v69, s74
    v_perm_b32 v208, v74, v70, s73
    v_perm_b32 v212, v74, v70, s74
    v_perm_b32 v216, v75, v71, s73
    v_perm_b32 v220, v75, v71, s74
    s_waitcnt vmcnt(14)
    buffer_load_dwordx4 v[56:59], v3, s[48:51], s72 offen offset:1024 nt
    v_dot2_f32_bf16 v31, v76, v10, 0
    v_dot2_f32_bf16 v31, v77, v11, v31
    v_dot2_f32_bf16 v31, v78, v12, v31
    v_dot2_f32_bf16 v31, v79, v13, v31
    v_add_f32_dpp v32, v30, v30 row_ror:8 row_mask:0xf bank_mask:0x3
    s_nop 1
    v_add_f32_dpp v32, v31, v31 row_ror:8 row_mask:0xf bank_mask:0xc
    s_waitcnt vmcnt(14)
    s_add_u32 s67, s68, s69
    buffer_load_dwordx4 v[60:63], v1, s[36:39], s67 offen nt
    s_add_u32 s69, s69, 1024
    s_and_b32 s69, s69, 0xfc00
    s_waitcnt vmcnt(14)
    buffer_load_dwordx4 v[64:67], v3, s[48:51], s72 offen offset:2048 nt
    v_dot2_f32_bf16 v30, v80, v10, 0
    v_dot2_f32_bf16 v30, v81, v11, v30
    v_dot2_f32_bf16 v30, v82, v12, v30
    v_dot2_f32_bf16 v30, v83, v13, v30
    s_waitcnt vmcnt(14)
    s_add_u32 s67, s68, s69
    buffer_load_dwordx4 v[68:71], v1, s[36:39], s67 offen nt
    s_add_u32 s69, s69, 1024
    s_and_b32 s69, s69, 0xfc00
    v_perm_b32 v193, v88, v84, s73
    v_perm_b32 v197, v88, v84, s74
    v_perm_b32 v201, v89, v85, s73
    v_perm_b32 v205, v89, v85, s74
    v_perm_b32 v209, v90, v86, s73
    v_perm_b32 v213, v90, v86, s74
    v_perm_b32 v217, v91, v87, s73
    v_perm_b32 v221, v91, v87, s74
    s_waitcnt vmcnt(14)
    buffer_load_dwordx4 v[72:75], v3, s[48:51], s72 offen offset:3072 nt
    s_add_u32 s72, s72, 4096
    v_dot2_f32_bf16 v31, v92, v10, 0
    v_dot2_f32_bf16 v31, v93, v11, v31
    v_dot2_f32_bf16 v31, v94, v12, v31
    v_dot2_f32_bf16 v31, v95, v13, v31
    v_add_f32_dpp v33, v30, v30 row_ror:8 row_mask:0xf bank_mask:0x3
    s_nop 1
    v_add_f32_dpp v33, v31, v31 row_ror:8 row_mask:0xf bank_mask:0xc
    v_add_f32_dpp v34, v32, v32 row_half_mirror row_mask:0xf bank_mask:0x5
    s_nop 0
    v_add_f32_dpp v34, v33, v33 row_half_mirror row_mask:0xf bank_mask:0xa
    s_waitcnt vmcnt(14)
    s_add_u32 s67, s68, s69
    buffer_load_dwordx4 v[76:79], v1, s[36:39], s67 offen nt
    s_add_u32 s69, s69, 1024
    s_and_b32 s69, s69, 0xfc00
    s_waitcnt vmcnt(14)
    buffer_load_dwordx4 v[80:83], v3, s[48:51], s72 offen offset:0 nt
    v_dot2_f32_bf16 v30, v100, v10, 0
    v_dot2_f32_bf16 v30, v101, v11, v30
    v_dot2_f32_bf16 v30, v102, v12, v30
    v_dot2_f32_bf16 v30, v103, v13, v30
    s_waitcnt vmcnt(14)
    s_add_u32 s67, s68, s69
    buffer_load_dwordx4 v[84:87], v1, s[36:39], s67 offen nt
    s_add_u32 s69, s69, 1024
    s_and_b32 s69, s69, 0xfc00
    v_perm_b32 v194, v104, v96, s73
    v_perm_b32 v198, v104, v96, s74
    v_perm_b32 v202, v105, v97, s73
    v_perm_b32 v206, v105, v97, s74
    v_perm_b32 v210, v106, v98, s73
    v_perm_b32 v214, v106, v98, s74
    v_perm_b32 v218, v107, v99, s73
    v_perm_b32 v222, v107, v99, s74
    s_waitcnt vmcnt(14)
    buffer_load_dwordx4 v[88:91], v3, s[48:51], s72 offen offset:1024 nt
    v_dot2_f32_bf16 v31, v108, v10, 0
    v_dot2_f32_bf16 v31, v109, v11, v31
    v_dot2_f32_bf16 v31, v110, v12, v31
    v_dot2_f32_bf16 v31, v111, v13, v31
    v_add_f32_dpp v32, v30, v30 row_ror:8 row_mask:0xf bank_mask:0x3
    s_nop 1
    v_add_f32_dpp v32, v31, v31 row_ror:8 row_mask:0xf bank_mask:0xc
    s_waitcnt vmcnt(14)
    s_add_u32 s67, s68, s69
    buffer_load_dwordx4 v[92:95], v1, s[36:39], s67 offen nt
    s_add_u32 s69, s69, 1024
    s_and_b32 s69, s69, 0xfc00
    s_waitcnt vmcnt(14)
    buffer_load_dwordx4 v[100:103], v3, s[48:51], s72 offen offset:2048 nt
    v_dot2_f32_bf16 v30, v116, v10, 0
    v_dot2_f32_bf16 v30, v117, v11, v30
    v_dot2_f32_bf16 v30, v118, v12, v30
    v_dot2_f32_bf16 v30, v119, v13, v30
    s_waitcnt vmcnt(14)
    s_add_u32 s67, s68, s69
    buffer_load_dwordx4 v[96:99], v1, s[36:39], s67 offen nt
    s_add_u32 s69, s69, 1024
    s_and_b32 s69, s69, 0xfc00
    v_perm_b32 v195, v120, v112, s73
    v_perm_b32 v199, v120, v112, s74
    v_perm_b32 v203, v121, v113, s73
    v_perm_b32 v207, v121, v113, s74
    v_perm_b32 v211, v122, v114, s73
    v_perm_b32 v215, v122, v114, s74
    v_perm_b32 v219, v123, v115, s73
    v_perm_b32 v223, v123, v115, s74
    s_waitcnt vmcnt(14)
    buffer_load_dwordx4 v[104:107], v3, s[48:51], s72 offen offset:3072 nt
    v_dot2_f32_bf16 v31, v124, v10, 0
    v_dot2_f32_bf16 v31, v125, v11, v31
    v_dot2_f32_bf16 v31, v126, v12, v31
    v_dot2_f32_bf16 v31, v127, v13, v31
    v_add_f32_dpp v33, v30, v30 row_ror:8 row_mask:0xf bank_mask:0x3
    s_nop 1
    v_add_f32_dpp v33, v31, v31 row_ror:8 row_mask:0xf bank_mask:0xc
    v_add_f32_dpp v35, v32, v32 row_half_mirror row_mask:0xf bank_mask:0x5
    s_nop 0
    v_add_f32_dpp v35, v33, v33 row_half_mirror row_mask:0xf bank_mask:0xa
    v_add_f32_dpp v4, v34, v34 quad_perm:[2,3,0,1] row_mask:0xf bank_mask:0xf
    s_nop 0
    v_add_f32_dpp v5, v35, v35 quad_perm:[2,3,0,1] row_mask:0xf bank_mask:0xf
    v_cndmask_b32 v36, v4, v5, s[78:79]
    s_waitcnt vmcnt(14)
    s_add_u32 s67, s68, s69
    buffer_load_dwordx4 v[108:111], v1, s[36:39], s67 offen nt
    s_waitcnt vmcnt(14)
    s_add_u32 s67, s68, s70
    buffer_load_dwordx4 a[128:131], v1, s[40:43], s67 offen nt
    s_add_u32 s70, s70, 1024
    s_and_b32 s70, s70, 0xfc00
    v_dot2_f32_bf16 v30, v52, v10, 0
    v_dot2_f32_bf16 v30, v53, v11, v30
    v_dot2_f32_bf16 v30, v54, v12, v30
    v_dot2_f32_bf16 v30, v55, v13, v30
    s_waitcnt vmcnt(14)
    s_add_u32 s67, s68, s70
    buffer_load_dwordx4 a[132:135], v1, s[40:43], s67 offen nt
    s_add_u32 s70, s70, 1024
    s_and_b32 s70, s70, 0xfc00
    v_perm_b32 v224, v56, v48, s73
    v_perm_b32 v228, v56, v48, s74
    v_perm_b32 v232, v57, v49, s73
    v_perm_b32 v236, v57, v49, s74
    v_perm_b32 v240, v58, v50, s73
    v_perm_b32 v244, v58, v50, s74
    v_perm_b32 v248, v59, v51, s73
    v_perm_b32 v252, v59, v51, s74
    s_waitcnt vmcnt(14)
    s_add_u32 s67, s68, s70
    buffer_load_dwordx4 a[136:139], v1, s[40:43], s67 offen nt
    s_add_u32 s70, s70, 1024
    s_and_b32 s70, s70, 0xfc00
    v_dot2_f32_bf16 v31, v60, v10, 0
    v_dot2_f32_bf16 v31, v61, v11, v31
    v_dot2_f32_bf16 v31, v62, v12, v31
    v_dot2_f32_bf16 v31, v63, v13, v31
    v_add_f32_dpp v32, v30, v30 row_ror:8 row_mask:0xf bank_mask:0x3
    s_nop 1
    v_add_f32_dpp v32, v31, v31 row_ror:8 row_mask:0xf bank_mask:0xc
    s_waitcnt vmcnt(14)
    s_add_u32 s67, s68, s70
    buffer_load_dwordx4 a[140:143], v1, s[40:43], s67 offen nt
    s_add_u32 s70, s70, 1024
    s_and_b32 s70, s70, 0xfc00
    s_waitcnt vmcnt(14)
    s_add_u32 s67, s68, s70
    buffer_load_dwordx4 a[144:147], v1, s[40:43], s67 offen nt
    s_add_u32 s70, s70, 1024
    s_and_b32 s70, s70, 0xfc00
    v_dot2_f32_bf16 v30, v68, v10, 0
    v_dot2_f32_bf16 v30, v69, v11, v30
    v_dot2_f32_bf16 v30, v70, v12, v30
    v_dot2_f32_bf16 v30, v71, v13, v30
    s_waitcnt vmcnt(14)
    s_add_u32 s67, s68, s70
    buffer_load_dwordx4 a[148:151], v1, s[40:43], s67 offen nt
    s_add_u32 s70, s70, 1024
    s_and_b32 s70, s70, 0xfc00
    v_perm_b32 v225, v72, v64, s73
    v_perm_b32 v229, v72, v64, s74
    v_perm_b32 v233, v73, v65, s73
    v_perm_b32 v237, v73, v65, s74
    v_perm_b32 v241, v74, v66, s73
    v_perm_b32 v245, v74, v66, s74
    v_perm_b32 v249, v75, v67, s73
    v_perm_b32 v253, v75, v67, s74
    s_waitcnt vmcnt(14)
    s_add_u32 s67, s68, s70
    buffer_load_dwordx4 a[152:155], v1, s[40:43], s67 offen nt
    s_add_u32 s70, s70, 1024
    s_and_b32 s70, s70, 0xfc00
    v_dot2_f32_bf16 v31, v76, v10, 0
    v_dot2_f32_bf16 v31, v77, v11, v31
    v_dot2_f32_bf16 v31, v78, v12, v31
    v_dot2_f32_bf16 v31, v79, v13, v31
    v_add_f32_dpp v33, v30, v30 row_ror:8 row_mask:0xf bank_mask:0x3
    s_nop 1
    v_add_f32_dpp v33, v31, v31 row_ror:8 row_mask:0xf bank_mask:0xc
    v_add_f32_dpp v34, v32, v32 row_half_mirror row_mask:0xf bank_mask:0x5
    s_nop 0
    v_add_f32_dpp v34, v33, v33 row_half_mirror row_mask:0xf bank_mask:0xa
    s_waitcnt vmcnt(14)
    s_add_u32 s67, s68, s70
    buffer_load_dwordx4 a[156:159], v1, s[40:43], s67 offen nt
    s_add_u32 s70, s70, 1024
    s_and_b32 s70, s70, 0xfc00
    s_waitcnt vmcnt(14)
    s_add_u32 s67, s68, s70
    buffer_load_dwordx4 a[160:163], v1, s[40:43], s67 offen nt
    s_add_u32 s70, s70, 1024
    s_and_b32 s70, s70, 0xfc00
    v_dot2_f32_bf16 v30, v84, v10, 0
    v_dot2_f32_bf16 v30, v85, v11, v30
    v_dot2_f32_bf16 v30, v86, v12, v30
    v_dot2_f32_bf16 v30, v87, v13, v30
    s_waitcnt vmcnt(14)
    s_add_u32 s67, s68, s70
    buffer_load_dwordx4 a[164:167], v1, s[40:43], s67 offen nt
    s_add_u32 s70, s70, 1024
    s_and_b32 s70, s70, 0xfc00
    v_perm_b32 v226, v88, v80, s73
    v_perm_b32 v230, v88, v80, s74
    v_perm_b32 v234, v89, v81, s73
    v_perm_b32 v238, v89, v81, s74
    v_perm_b32 v242, v90, v82, s73
    v_perm_b32 v246, v90, v82, s74
    v_perm_b32 v250, v91, v83, s73
    v_perm_b32 v254, v91, v83, s74
    s_waitcnt vmcnt(14)
    s_add_u32 s67, s68, s70
    buffer_load_dwordx4 a[168:171], v1, s[40:43], s67 offen nt
    s_add_u32 s70, s70, 1024
    s_and_b32 s70, s70, 0xfc00
    v_dot2_f32_bf16 v31, v92, v10, 0
    v_dot2_f32_bf16 v31, v93, v11, v31
    v_dot2_f32_bf16 v31, v94, v12, v31
    v_dot2_f32_bf16 v31, v95, v13, v31
    v_add_f32_dpp v32, v30, v30 row_ror:8 row_mask:0xf bank_mask:0x3
    s_nop 1
    v_add_f32_dpp v32, v31, v31 row_ror:8 row_mask:0xf bank_mask:0xc
    s_waitcnt vmcnt(14)
    s_add_u32 s67, s68, s70
    buffer_load_dwordx4 a[172:175], v1, s[40:43], s67 offen nt
    s_add_u32 s70, s70, 1024
    s_and_b32 s70, s70, 0xfc00
    s_waitcnt vmcnt(14)
    s_add_u32 s67, s68, s70
    buffer_load_dwordx4 a[176:179], v1, s[40:43], s67 offen nt
    s_add_u32 s70, s70, 1024
    s_and_b32 s70, s70, 0xfc00
    v_dot2_f32_bf16 v30, v96, v10, 0
    v_dot2_f32_bf16 v30, v97, v11, v30
    v_dot2_f32_bf16 v30, v98, v12, v30
    v_dot2_f32_bf16 v30, v99, v13, v30
    s_waitcnt vmcnt(14)
    s_add_u32 s67, s68, s70
    buffer_load_dwordx4 a[180:183], v1, s[40:43], s67 offen nt
    s_add_u32 s70, s70, 1024
    s_and_b32 s70, s70, 0xfc00
    v_perm_b32 v227, v104, v100, s73
    v_perm_b32 v231, v104, v100, s74
    v_perm_b32 v235, v105, v101, s73
    v_perm_b32 v239, v105, v101, s74
    v_perm_b32 v243, v106, v102, s73
    v_perm_b32 v247, v106, v102, s74
    v_perm_b32 v251, v107, v103, s73
    v_perm_b32 v255, v107, v103, s74
    s_waitcnt vmcnt(14)
    s_add_u32 s67, s68, s70
    buffer_load_dwordx4 a[184:187], v1, s[40:43], s67 offen nt
    s_add_u32 s70, s70, 1024
    s_and_b32 s70, s70, 0xfc00
    s_add_u32 s67, s68, s70
    buffer_load_dwordx4 a[188:191], v1, s[40:43], s67 offen nt
    s_add_u32 s70, s70, 1024
    s_and_b32 s70, s70, 0xfc00
    s_add_u32 s67, s68, s70
    buffer_load_dwordx4 a[192:195], v1, s[40:43], s67 offen nt
    s_add_u32 s70, s70, 1024
    s_and_b32 s70, s70, 0xfc00
    s_add_u32 s67, s68, s70
    buffer_load_dwordx4 a[196:199], v1, s[40:43], s67 offen nt
    s_add_u32 s70, s70, 1024
    s_and_b32 s70, s70, 0xfc00
    s_add_u32 s67, s68, s70
    buffer_load_dwordx4 a[200:203], v1, s[40:43], s67 offen nt
    s_add_u32 s70, s70, 1024
    s_and_b32 s70, s70, 0xfc00
    s_add_u32 s67, s68, s70
    buffer_load_dwordx4 a[204:207], v1, s[40:43], s67 offen nt
    s_add_u32 s70, s70, 1024
    s_and_b32 s70, s70, 0xfc00
    s_add_u32 s67, s68, s70
    buffer_load_dwordx4 a[208:211], v1, s[40:43], s67 offen nt
    s_add_u32 s70, s70, 1024
    s_and_b32 s70, s70, 0xfc00
    v_dot2_f32_bf16 v31, v108, v10, 0
    v_dot2_f32_bf16 v31, v109, v11, v31
    v_dot2_f32_bf16 v31, v110, v12, v31
    v_dot2_f32_bf16 v31, v111, v13, v31
    v_add_f32_dpp v33, v30, v30 row_ror:8 row_mask:0xf bank_mask:0x3
    s_nop 1
    v_add_f32_dpp v33, v31, v31 row_ror:8 row_mask:0xf bank_mask:0xc
    v_add_f32_dpp v35, v32, v32 row_half_mirror row_mask:0xf bank_mask:0x5
    s_nop 0
    v_add_f32_dpp v35, v33, v33 row_half_mirror row_mask:0xf bank_mask:0xa
    v_add_f32_dpp v4, v34, v34 quad_perm:[2,3,0,1] row_mask:0xf bank_mask:0xf
    s_nop 0
    v_add_f32_dpp v5, v35, v35 quad_perm:[2,3,0,1] row_mask:0xf bank_mask:0xf
    v_cndmask_b32 v37, v4, v5, s[78:79]
    v_add_f32_dpp v4, v36, v36 quad_perm:[1,0,3,2] row_mask:0xf bank_mask:0xf
    s_nop 0
    v_add_f32_dpp v5, v37, v37 quad_perm:[1,0,3,2] row_mask:0xf bank_mask:0xf
    v_cndmask_b32 v29, v4, v5, s[80:81]
    v_cvt_pk_bf16_f32 v29, v29, v29
    v_and_b32 v29, 0xffff0000, v29
    v_mul_f32 v29, 0x3db504f3, v29
    v_cvt_pk_bf16_f32 v29, v29, v29
    v_and_b32 v29, 0xffff0000, v29
    v_max3_f32 v5, v26, v27, v28
    v_max_f32 v5, v5, v29
    s_nop 1
    v_max_f32_dpp v4, v5, v5 row_ror:8 row_mask:0xf bank_mask:0xf
    s_nop 1
    v_max_f32_dpp v4, v4, v4 row_ror:4 row_mask:0xf bank_mask:0xf
    s_nop 1
    v_max_f32_dpp v4, v4, v4 row_ror:2 row_mask:0xf bank_mask:0xf
    s_nop 1
    v_max_f32_dpp v4, v4, v4 row_ror:1 row_mask:0xf bank_mask:0xf
    v_mov_b32 v5, v4
    s_nop 1
    v_permlane16_swap_b32 v4, v5
    v_max_f32 v4, v4, v5
    v_mov_b32 v5, v4
    s_nop 1
    v_permlane32_swap_b32 v4, v5
    v_max_f32 v4, v4, v5
    s_lshl_b32 s65, s63, 2
    v_mov_b32 v5, s65
    ds_write_b32 v5, v4 offset:2048
    v_mov_b32 v5, 0
    s_waitcnt lgkmcnt(0)
    s_barrier
    ds_read_b128 v[32:35], v5 offset:2048
    s_cmp_lg_u32 s61, 0
    s_cbranch_scc1 L_nocnt
    s_lshl_b32 s65, s62, 7
    buffer_load_dword v30, v5, s[56:59], s65 offen sc1
L_nocnt:
    s_waitcnt lgkmcnt(0)
    v_max3_f32 v31, v32, v33, v34
    v_max_f32 v31, v31, v35
    v_sub_f32 v26, v26, v31
    v_sub_f32 v27, v27, v31
    v_sub_f32 v28, v28, v31
    v_sub_f32 v29, v29, v31
    v_mul_f32 v26, 0x3fb8aa3b, v26
    v_mul_f32 v27, 0x3fb8aa3b, v27
    v_mul_f32 v28, 0x3fb8aa3b, v28
    v_mul_f32 v29, 0x3fb8aa3b, v29
    v_exp_f32 v26, v26
    v_exp_f32 v27, v27
    v_exp_f32 v28, v28
    v_exp_f32 v29, v29
    s_nop 0
    v_add_f32 v32, v26, v27
    v_add_f32 v33, v28, v29
    v_add_f32 v32, v32, v33
    v_cvt_pk_bf16_f32 v26, v26, v26
    v_cvt_pk_bf16_f32 v27, v27, v27
    v_cvt_pk_bf16_f32 v28, v28, v28
    v_cvt_pk_bf16_f32 v29, v29, v29
    s_nop 1
    v_add_f32_dpp v33, v32, v32 row_ror:8 row_mask:0xf bank_mask:0xf
    s_nop 1
    v_add_f32_dpp v33, v33, v33 row_ror:4 row_mask:0xf bank_mask:0xf
    s_nop 1
    v_add_f32_dpp v33, v33, v33 row_ror:2 row_mask:0xf bank_mask:0xf
    s_nop 1
    v_add_f32_dpp v33, v33, v33 row_ror:1 row_mask:0xf bank_mask:0xf
    v_mov_b32 v34, v33
    s_nop 1
    v_permlane16_swap_b32 v33, v34
    v_add_f32 v33, v33, v34
    v_mov_b32 v34, v33
    s_nop 1
    v_permlane32_swap_b32 v33, v34
    v_add_f32 v33, v33, v34
    v_min_u32 v32, -2, v31
    v_min_u32 v33, -2, v33
    s_mov_b64 exec, 1
    buffer_store_dwordx2 v[32:33], v5, s[52:55], s64 offen sc1
    s_mov_b64 exec, -1
    v_and_b32_dpp v14, v28, v6 row_newbcast:0 row_mask:0xf bank_mask:0xf
    v_and_b32_dpp v15, v28, v7 row_newbcast:0 row_mask:0xf bank_mask:0xf
    v_and_b32_dpp v16, v28, v8 row_newbcast:0 row_mask:0xf bank_mask:0xf
    v_and_b32_dpp v17, v28, v9 row_newbcast:0 row_mask:0xf bank_mask:0xf
    s_waitcnt vmcnt(21)
    s_nop 0
    v_mfma_f32_16x16x32_bf16 v[22:25], v[14:17], a[128:131], 0
    v_and_b32_dpp v18, v26, v6 row_newbcast:0 row_mask:0xf bank_mask:0xf
    v_and_b32_dpp v19, v26, v7 row_newbcast:0 row_mask:0xf bank_mask:0xf
    v_and_b32_dpp v20, v26, v8 row_newbcast:0 row_mask:0xf bank_mask:0xf
    v_and_b32_dpp v21, v26, v9 row_newbcast:0 row_mask:0xf bank_mask:0xf
    s_nop 1
    v_mfma_f32_16x16x32_bf16 v[22:25], v[18:21], a[0:3], v[22:25]
    v_and_b32_dpp v14, v26, v6 row_newbcast:8 row_mask:0xf bank_mask:0xf
    v_and_b32_dpp v15, v26, v7 row_newbcast:8 row_mask:0xf bank_mask:0xf
    v_and_b32_dpp v16, v26, v8 row_newbcast:8 row_mask:0xf bank_mask:0xf
    v_and_b32_dpp v17, v26, v9 row_newbcast:8 row_mask:0xf bank_mask:0xf
    s_nop 1
    v_mfma_f32_16x16x32_bf16 v[22:25], v[14:17], a[4:7], v[22:25]
    v_and_b32_dpp v18, v28, v6 row_newbcast:8 row_mask:0xf bank_mask:0xf
    v_and_b32_dpp v19, v28, v7 row_newbcast:8 row_mask:0xf bank_mask:0xf
    v_and_b32_dpp v20, v28, v8 row_newbcast:8 row_mask:0xf bank_mask:0xf
    v_and_b32_dpp v21, v28, v9 row_newbcast:8 row_mask:0xf bank_mask:0xf
    s_waitcnt vmcnt(20)
    s_nop 0
    v_mfma_f32_16x16x32_bf16 v[22:25], v[18:21], a[132:135], v[22:25]
    v_and_b32_dpp v14, v26, v6 row_newbcast:4 row_mask:0xf bank_mask:0xf
    v_and_b32_dpp v15, v26, v7 row_newbcast:4 row_mask:0xf bank_mask:0xf
    v_and_b32_dpp v16, v26, v8 row_newbcast:4 row_mask:0xf bank_mask:0xf
    v_and_b32_dpp v17, v26, v9 row_newbcast:4 row_mask:0xf bank_mask:0xf
    s_nop 1
    v_mfma_f32_16x16x32_bf16 v[22:25], v[14:17], a[8:11], v[22:25]
    v_and_b32_dpp v18, v26, v6 row_newbcast:12 row_mask:0xf bank_mask:0xf
    v_and_b32_dpp v19, v26, v7 row_newbcast:12 row_mask:0xf bank_mask:0xf
    v_and_b32_dpp v20, v26, v8 row_newbcast:12 row_mask:0xf bank_mask:0xf
    v_and_b32_dpp v21, v26, v9 row_newbcast:12 row_mask:0xf bank_mask:0xf
    s_nop 1
    v_mfma_f32_16x16x32_bf16 v[22:25], v[18:21], a[12:15], v[22:25]
    v_and_b32_dpp v14, v28, v6 row_newbcast:4 row_mask:0xf bank_mask:0xf
    v_and_b32_dpp v15, v28, v7 row_newbcast:4 row_mask:0xf bank_mask:0xf
    v_and_b32_dpp v16, v28, v8 row_newbcast:4 row_mask:0xf bank_mask:0xf
    v_and_b32_dpp v17, v28, v9 row_newbcast:4 row_mask:0xf bank_mask:0xf
    s_waitcnt vmcnt(19)
    s_nop 0
    v_mfma_f32_16x16x32_bf16 v[22:25], v[14:17], a[136:139], v[22:25]
    v_and_b32_dpp v18, v26, v6 row_newbcast:2 row_mask:0xf bank_mask:0xf
    v_and_b32_dpp v19, v26, v7 row_newbcast:2 row_mask:0xf bank_mask:0xf
    v_and_b32_dpp v20, v26, v8 row_newbcast:2 row_mask:0xf bank_mask:0xf
    v_and_b32_dpp v21, v26, v9 row_newbcast:2 row_mask:0xf bank_mask:0xf
    s_nop 1
    v_mfma_f32_16x16x32_bf16 v[22:25], v[18:21], a[16:19], v[22:25]
    v_and_b32_dpp v14, v26, v6 row_newbcast:10 row_mask:0xf bank_mask:0xf
    v_and_b32_dpp v15, v26, v7 row_newbcast:10 row_mask:0xf bank_mask:0xf
    v_and_b32_dpp v16, v26, v8 row_newbcast:10 row_mask:0xf bank_mask:0xf
    v_and_b32_dpp v17, v26, v9 row_newbcast:10 row_mask:0xf bank_mask:0xf
    s_nop 1
    v_mfma_f32_16x16x32_bf16 v[22:25], v[14:17], a[20:23], v[22:25]
    v_and_b32_dpp v18, v28, v6 row_newbcast:12 row_mask:0xf bank_mask:0xf
    v_and_b32_dpp v19, v28, v7 row_newbcast:12 row_mask:0xf bank_mask:0xf
    v_and_b32_dpp v20, v28, v8 row_newbcast:12 row_mask:0xf bank_mask:0xf
    v_and_b32_dpp v21, v28, v9 row_newbcast:12 row_mask:0xf bank_mask:0xf
    s_waitcnt vmcnt(18)
    s_nop 0
    v_mfma_f32_16x16x32_bf16 v[22:25], v[18:21], a[140:143], v[22:25]
    v_and_b32_dpp v14, v26, v6 row_newbcast:6 row_mask:0xf bank_mask:0xf
    v_and_b32_dpp v15, v26, v7 row_newbcast:6 row_mask:0xf bank_mask:0xf
    v_and_b32_dpp v16, v26, v8 row_newbcast:6 row_mask:0xf bank_mask:0xf
    v_and_b32_dpp v17, v26, v9 row_newbcast:6 row_mask:0xf bank_mask:0xf
    s_nop 1
    v_mfma_f32_16x16x32_bf16 v[22:25], v[14:17], a[24:27], v[22:25]
    v_and_b32_dpp v18, v26, v6 row_newbcast:14 row_mask:0xf bank_mask:0xf
    v_and_b32_dpp v19, v26, v7 row_newbcast:14 row_mask:0xf bank_mask:0xf
    v_and_b32_dpp v20, v26, v8 row_newbcast:14 row_mask:0xf bank_mask:0xf
    v_and_b32_dpp v21, v26, v9 row_newbcast:14 row_mask:0xf bank_mask:0xf
    s_nop 1
    v_mfma_f32_16x16x32_bf16 v[22:25], v[18:21], a[28:31], v[22:25]
    v_and_b32_dpp v14, v28, v6 row_newbcast:2 row_mask:0xf bank_mask:0xf
    v_and_b32_dpp v15, v28, v7 row_newbcast:2 row_mask:0xf bank_mask:0xf
    v_and_b32_dpp v16, v28, v8 row_newbcast:2 row_mask:0xf bank_mask:0xf
    v_and_b32_dpp v17, v28, v9 row_newbcast:2 row_mask:0xf bank_mask:0xf
    s_waitcnt vmcnt(17)
    s_nop 0
    v_mfma_f32_16x16x32_bf16 v[22:25], v[14:17], a[144:147], v[22:25]
    v_and_b32_dpp v18, v26, v6 row_newbcast:1 row_mask:0xf bank_mask:0xf
    v_and_b32_dpp v19, v26, v7 row_newbcast:1 row_mask:0xf bank_mask:0xf
    v_and_b32_dpp v20, v26, v8 row_newbcast:1 row_mask:0xf bank_mask:0xf
    v_and_b32_dpp v21, v26, v9 row_newbcast:1 row_mask:0xf bank_mask:0xf
    s_nop 1
    v_mfma_f32_16x16x32_bf16 v[22:25], v[18:21], a[32:35], v[22:25]
    v_and_b32_dpp v14, v26, v6 row_newbcast:9 row_mask:0xf bank_mask:0xf
    v_and_b32_dpp v15, v26, v7 row_newbcast:9 row_mask:0xf bank_mask:0xf
    v_and_b32_dpp v16, v26, v8 row_newbcast:9 row_mask:0xf bank_mask:0xf
    v_and_b32_dpp v17, v26, v9 row_newbcast:9 row_mask:0xf bank_mask:0xf
    s_nop 1
    v_mfma_f32_16x16x32_bf16 v[22:25], v[14:17], a[36:39], v[22:25]
    v_and_b32_dpp v18, v28, v6 row_newbcast:10 row_mask:0xf bank_mask:0xf
    v_and_b32_dpp v19, v28, v7 row_newbcast:10 row_mask:0xf bank_mask:0xf
    v_and_b32_dpp v20, v28, v8 row_newbcast:10 row_mask:0xf bank_mask:0xf
    v_and_b32_dpp v21, v28, v9 row_newbcast:10 row_mask:0xf bank_mask:0xf
    s_waitcnt vmcnt(16)
    s_nop 0
    v_mfma_f32_16x16x32_bf16 v[22:25], v[18:21], a[148:151], v[22:25]
    v_and_b32_dpp v14, v26, v6 row_newbcast:5 row_mask:0xf bank_mask:0xf
    v_and_b32_dpp v15, v26, v7 row_newbcast:5 row_mask:0xf bank_mask:0xf
    v_and_b32_dpp v16, v26, v8 row_newbcast:5 row_mask:0xf bank_mask:0xf
    v_and_b32_dpp v17, v26, v9 row_newbcast:5 row_mask:0xf bank_mask:0xf
    s_nop 1
    v_mfma_f32_16x16x32_bf16 v[22:25], v[14:17], a[40:43], v[22:25]
    v_and_b32_dpp v18, v26, v6 row_newbcast:13 row_mask:0xf bank_mask:0xf
    v_and_b32_dpp v19, v26, v7 row_newbcast:13 row_mask:0xf bank_mask:0xf
    v_and_b32_dpp v20, v26, v8 row_newbcast:13 row_mask:0xf bank_mask:0xf
    v_and_b32_dpp v21, v26, v9 row_newbcast:13 row_mask:0xf bank_mask:0xf
    s_nop 1
    v_mfma_f32_16x16x32_bf16 v[22:25], v[18:21], a[44:47], v[22:25]
    v_and_b32_dpp v14, v28, v6 row_newbcast:6 row_mask:0xf bank_mask:0xf
    v_and_b32_dpp v15, v28, v7 row_newbcast:6 row_mask:0xf bank_mask:0xf
    v_and_b32_dpp v16, v28, v8 row_newbcast:6 row_mask:0xf bank_mask:0xf
    v_and_b32_dpp v17, v28, v9 row_newbcast:6 row_mask:0xf bank_mask:0xf
    s_waitcnt vmcnt(15)
    s_add_u32 s67, s68, s70
    buffer_load_dwordx4 a[212:215], v1, s[40:43], s67 offen nt
    s_add_u32 s70, s70, 1024
    s_and_b32 s70, s70, 0xfc00
    v_mfma_f32_16x16x32_bf16 v[22:25], v[14:17], a[152:155], v[22:25]
    v_and_b32_dpp v18, v26, v6 row_newbcast:3 row_mask:0xf bank_mask:0xf
    v_and_b32_dpp v19, v26, v7 row_newbcast:3 row_mask:0xf bank_mask:0xf
    v_and_b32_dpp v20, v26, v8 row_newbcast:3 row_mask:0xf bank_mask:0xf
    v_and_b32_dpp v21, v26, v9 row_newbcast:3 row_mask:0xf bank_mask:0xf
    s_nop 1
    v_mfma_f32_16x16x32_bf16 v[22:25], v[18:21], a[48:51], v[22:25]
    v_and_b32_dpp v14, v26, v6 row_newbcast:11 row_mask:0xf bank_mask:0xf
    v_and_b32_dpp v15, v26, v7 row_newbcast:11 row_mask:0xf bank_mask:0xf
    v_and_b32_dpp v16, v26, v8 row_newbcast:11 row_mask:0xf bank_mask:0xf
    v_and_b32_dpp v17, v26, v9 row_newbcast:11 row_mask:0xf bank_mask:0xf
    s_nop 1
    v_mfma_f32_16x16x32_bf16 v[22:25], v[14:17], a[52:55], v[22:25]
    v_and_b32_dpp v18, v28, v6 row_newbcast:14 row_mask:0xf bank_mask:0xf
    v_and_b32_dpp v19, v28, v7 row_newbcast:14 row_mask:0xf bank_mask:0xf
    v_and_b32_dpp v20, v28, v8 row_newbcast:14 row_mask:0xf bank_mask:0xf
    v_and_b32_dpp v21, v28, v9 row_newbcast:14 row_mask:0xf bank_mask:0xf
    s_waitcnt vmcnt(15)
    s_add_u32 s67, s68, s70
    buffer_load_dwordx4 a[216:219], v1, s[40:43], s67 offen nt
    s_add_u32 s70, s70, 1024
    s_and_b32 s70, s70, 0xfc00
    v_mfma_f32_16x16x32_bf16 v[22:25], v[18:21], a[156:159], v[22:25]
    v_and_b32_dpp v14, v26, v6 row_newbcast:7 row_mask:0xf bank_mask:0xf
    v_and_b32_dpp v15, v26, v7 row_newbcast:7 row_mask:0xf bank_mask:0xf
    v_and_b32_dpp v16, v26, v8 row_newbcast:7 row_mask:0xf bank_mask:0xf
    v_and_b32_dpp v17, v26, v9 row_newbcast:7 row_mask:0xf bank_mask:0xf
    s_nop 1
    v_mfma_f32_16x16x32_bf16 v[22:25], v[14:17], a[56:59], v[22:25]
    v_and_b32_dpp v18, v26, v6 row_newbcast:15 row_mask:0xf bank_mask:0xf
    v_and_b32_dpp v19, v26, v7 row_newbcast:15 row_mask:0xf bank_mask:0xf
    v_and_b32_dpp v20, v26, v8 row_newbcast:15 row_mask:0xf bank_mask:0xf
    v_and_b32_dpp v21, v26, v9 row_newbcast:15 row_mask:0xf bank_mask:0xf
    s_nop 1
    v_mfma_f32_16x16x32_bf16 v[22:25], v[18:21], a[60:63], v[22:25]
    v_and_b32_dpp v14, v28, v6 row_newbcast:1 row_mask:0xf bank_mask:0xf
    v_and_b32_dpp v15, v28, v7 row_newbcast:1 row_mask:0xf bank_mask:0xf
    v_and_b32_dpp v16, v28, v8 row_newbcast:1 row_mask:0xf bank_mask:0xf
    v_and_b32_dpp v17, v28, v9 row_newbcast:1 row_mask:0xf bank_mask:0xf
    s_waitcnt vmcnt(15)
    s_add_u32 s67, s68, s70
    buffer_load_dwordx4 a[220:223], v1, s[40:43], s67 offen nt
    s_add_u32 s70, s70, 1024
    s_and_b32 s70, s70, 0xfc00
    v_mfma_f32_16x16x32_bf16 v[22:25], v[14:17], a[160:163], v[22:25]
    v_and_b32_dpp v18, v27, v6 row_newbcast:0 row_mask:0xf bank_mask:0xf
    v_and_b32_dpp v19, v27, v7 row_newbcast:0 row_mask:0xf bank_mask:0xf
    v_and_b32_dpp v20, v27, v8 row_newbcast:0 row_mask:0xf bank_mask:0xf
    v_and_b32_dpp v21, v27, v9 row_newbcast:0 row_mask:0xf bank_mask:0xf
    s_nop 1
    v_mfma_f32_16x16x32_bf16 v[22:25], v[18:21], a[64:67], v[22:25]
    v_and_b32_dpp v14, v27, v6 row_newbcast:8 row_mask:0xf bank_mask:0xf
    v_and_b32_dpp v15, v27, v7 row_newbcast:8 row_mask:0xf bank_mask:0xf
    v_and_b32_dpp v16, v27, v8 row_newbcast:8 row_mask:0xf bank_mask:0xf
    v_and_b32_dpp v17, v27, v9 row_newbcast:8 row_mask:0xf bank_mask:0xf
    s_nop 1
    v_mfma_f32_16x16x32_bf16 v[22:25], v[14:17], a[68:71], v[22:25]
    v_and_b32_dpp v18, v28, v6 row_newbcast:9 row_mask:0xf bank_mask:0xf
    v_and_b32_dpp v19, v28, v7 row_newbcast:9 row_mask:0xf bank_mask:0xf
    v_and_b32_dpp v20, v28, v8 row_newbcast:9 row_mask:0xf bank_mask:0xf
    v_and_b32_dpp v21, v28, v9 row_newbcast:9 row_mask:0xf bank_mask:0xf
    s_waitcnt vmcnt(15)
    s_add_u32 s67, s68, s70
    buffer_load_dwordx4 a[224:227], v1, s[40:43], s67 offen nt
    s_add_u32 s70, s70, 1024
    s_and_b32 s70, s70, 0xfc00
    v_mfma_f32_16x16x32_bf16 v[22:25], v[18:21], a[164:167], v[22:25]
    v_and_b32_dpp v14, v27, v6 row_newbcast:4 row_mask:0xf bank_mask:0xf
    v_and_b32_dpp v15, v27, v7 row_newbcast:4 row_mask:0xf bank_mask:0xf
    v_and_b32_dpp v16, v27, v8 row_newbcast:4 row_mask:0xf bank_mask:0xf
    v_and_b32_dpp v17, v27, v9 row_newbcast:4 row_mask:0xf bank_mask:0xf
    s_nop 1
    v_mfma_f32_16x16x32_bf16 v[22:25], v[14:17], a[72:75], v[22:25]
    v_and_b32_dpp v18, v27, v6 row_newbcast:12 row_mask:0xf bank_mask:0xf
    v_and_b32_dpp v19, v27, v7 row_newbcast:12 row_mask:0xf bank_mask:0xf
    v_and_b32_dpp v20, v27, v8 row_newbcast:12 row_mask:0xf bank_mask:0xf
    v_and_b32_dpp v21, v27, v9 row_newbcast:12 row_mask:0xf bank_mask:0xf
    s_nop 1
    v_mfma_f32_16x16x32_bf16 v[22:25], v[18:21], a[76:79], v[22:25]
    v_and_b32_dpp v14, v28, v6 row_newbcast:5 row_mask:0xf bank_mask:0xf
    v_and_b32_dpp v15, v28, v7 row_newbcast:5 row_mask:0xf bank_mask:0xf
    v_and_b32_dpp v16, v28, v8 row_newbcast:5 row_mask:0xf bank_mask:0xf
    v_and_b32_dpp v17, v28, v9 row_newbcast:5 row_mask:0xf bank_mask:0xf
    s_waitcnt vmcnt(15)
    s_add_u32 s67, s68, s70
    buffer_load_dwordx4 a[228:231], v1, s[40:43], s67 offen nt
    s_add_u32 s70, s70, 1024
    s_and_b32 s70, s70, 0xfc00
    v_mfma_f32_16x16x32_bf16 v[22:25], v[14:17], a[168:171], v[22:25]
    v_and_b32_dpp v18, v27, v6 row_newbcast:2 row_mask:0xf bank_mask:0xf
    v_and_b32_dpp v19, v27, v7 row_newbcast:2 row_mask:0xf bank_mask:0xf
    v_and_b32_dpp v20, v27, v8 row_newbcast:2 row_mask:0xf bank_mask:0xf
    v_and_b32_dpp v21, v27, v9 row_newbcast:2 row_mask:0xf bank_mask:0xf
    s_nop 1
    v_mfma_f32_16x16x32_bf16 v[22:25], v[18:21], a[80:83], v[22:25]
    v_and_b32_dpp v14, v27, v6 row_newbcast:10 row_mask:0xf bank_mask:0xf
    v_and_b32_dpp v15, v27, v7 row_newbcast:10 row_mask:0xf bank_mask:0xf
    v_and_b32_dpp v16, v27, v8 row_newbcast:10 row_mask:0xf bank_mask:0xf
    v_and_b32_dpp v17, v27, v9 row_newbcast:10 row_mask:0xf bank_mask:0xf
    s_nop 1
    v_mfma_f32_16x16x32_bf16 v[22:25], v[14:17], a[84:87], v[22:25]
    v_and_b32_dpp v18, v28, v6 row_newbcast:13 row_mask:0xf bank_mask:0xf
    v_and_b32_dpp v19, v28, v7 row_newbcast:13 row_mask:0xf bank_mask:0xf
    v_and_b32_dpp v20, v28, v8 row_newbcast:13 row_mask:0xf bank_mask:0xf
    v_and_b32_dpp v21, v28, v9 row_newbcast:13 row_mask:0xf bank_mask:0xf
    s_waitcnt vmcnt(15)
    s_add_u32 s67, s68, s70
    buffer_load_dwordx4 a[232:235], v1, s[40:43], s67 offen nt
    s_add_u32 s70, s70, 1024
    s_and_b32 s70, s70, 0xfc00
    v_mfma_f32_16x16x32_bf16 v[22:25], v[18:21], a[172:175], v[22:25]
    v_and_b32_dpp v14, v27, v6 row_newbcast:6 row_mask:0xf bank_mask:0xf
    v_and_b32_dpp v15, v27, v7 row_newbcast:6 row_mask:0xf bank_mask:0xf
    v_and_b32_dpp v16, v27, v8 row_newbcast:6 row_mask:0xf bank_mask:0xf
    v_and_b32_dpp v17, v27, v9 row_newbcast:6 row_mask:0xf bank_mask:0xf
    s_nop 1
    v_mfma_f32_16x16x32_bf16 v[22:25], v[14:17], a[88:91], v[22:25]
    v_and_b32_dpp v18, v27, v6 row_newbcast:14 row_mask:0xf bank_mask:0xf
    v_and_b32_dpp v19, v27, v7 row_newbcast:14 row_mask:0xf bank_mask:0xf
    v_and_b32_dpp v20, v27, v8 row_newbcast:14 row_mask:0xf bank_mask:0xf
    v_and_b32_dpp v21, v27, v9 row_newbcast:14 row_mask:0xf bank_mask:0xf
    s_nop 1
    v_mfma_f32_16x16x32_bf16 v[22:25], v[18:21], a[92:95], v[22:25]
    v_and_b32_dpp v14, v28, v6 row_newbcast:3 row_mask:0xf bank_mask:0xf
    v_and_b32_dpp v15, v28, v7 row_newbcast:3 row_mask:0xf bank_mask:0xf
    v_and_b32_dpp v16, v28, v8 row_newbcast:3 row_mask:0xf bank_mask:0xf
    v_and_b32_dpp v17, v28, v9 row_newbcast:3 row_mask:0xf bank_mask:0xf
    s_waitcnt vmcnt(15)
    s_add_u32 s67, s68, s70
    buffer_load_dwordx4 a[236:239], v1, s[40:43], s67 offen nt
    s_add_u32 s70, s70, 1024
    s_and_b32 s70, s70, 0xfc00
    v_mfma_f32_16x16x32_bf16 v[22:25], v[14:17], a[176:179], v[22:25]
    v_and_b32_dpp v18, v27, v6 row_newbcast:1 row_mask:0xf bank_mask:0xf
    v_and_b32_dpp v19, v27, v7 row_newbcast:1 row_mask:0xf bank_mask:0xf
    v_and_b32_dpp v20, v27, v8 row_newbcast:1 row_mask:0xf bank_mask:0xf
    v_and_b32_dpp v21, v27, v9 row_newbcast:1 row_mask:0xf bank_mask:0xf
    s_nop 1
    v_mfma_f32_16x16x32_bf16 v[22:25], v[18:21], a[96:99], v[22:25]
    v_and_b32_dpp v14, v27, v6 row_newbcast:9 row_mask:0xf bank_mask:0xf
    v_and_b32_dpp v15, v27, v7 row_newbcast:9 row_mask:0xf bank_mask:0xf
    v_and_b32_dpp v16, v27, v8 row_newbcast:9 row_mask:0xf bank_mask:0xf
    v_and_b32_dpp v17, v27, v9 row_newbcast:9 row_mask:0xf bank_mask:0xf
    s_nop 1
    v_mfma_f32_16x16x32_bf16 v[22:25], v[14:17], a[100:103], v[22:25]
    v_and_b32_dpp v18, v28, v6 row_newbcast:11 row_mask:0xf bank_mask:0xf
    v_and_b32_dpp v19, v28, v7 row_newbcast:11 row_mask:0xf bank_mask:0xf
    v_and_b32_dpp v20, v28, v8 row_newbcast:11 row_mask:0xf bank_mask:0xf
    v_and_b32_dpp v21, v28, v9 row_newbcast:11 row_mask:0xf bank_mask:0xf
    s_waitcnt vmcnt(15)
    s_add_u32 s67, s68, s70
    buffer_load_dwordx4 a[240:243], v1, s[40:43], s67 offen nt
    s_add_u32 s70, s70, 1024
    s_and_b32 s70, s70, 0xfc00
    v_mfma_f32_16x16x32_bf16 v[22:25], v[18:21], a[180:183], v[22:25]
    v_and_b32_dpp v14, v27, v6 row_newbcast:5 row_mask:0xf bank_mask:0xf
    v_and_b32_dpp v15, v27, v7 row_newbcast:5 row_mask:0xf bank_mask:0xf
    v_and_b32_dpp v16, v27, v8 row_newbcast:5 row_mask:0xf bank_mask:0xf
    v_and_b32_dpp v17, v27, v9 row_newbcast:5 row_mask:0xf bank_mask:0xf
    s_nop 1
    v_mfma_f32_16x16x32_bf16 v[22:25], v[14:17], a[104:107], v[22:25]
    v_and_b32_dpp v18, v27, v6 row_newbcast:13 row_mask:0xf bank_mask:0xf
    v_and_b32_dpp v19, v27, v7 row_newbcast:13 row_mask:0xf bank_mask:0xf
    v_and_b32_dpp v20, v27, v8 row_newbcast:13 row_mask:0xf bank_mask:0xf
    v_and_b32_dpp v21, v27, v9 row_newbcast:13 row_mask:0xf bank_mask:0xf
    s_nop 1
    v_mfma_f32_16x16x32_bf16 v[22:25], v[18:21], a[108:111], v[22:25]
    v_and_b32_dpp v14, v28, v6 row_newbcast:7 row_mask:0xf bank_mask:0xf
    v_and_b32_dpp v15, v28, v7 row_newbcast:7 row_mask:0xf bank_mask:0xf
    v_and_b32_dpp v16, v28, v8 row_newbcast:7 row_mask:0xf bank_mask:0xf
    v_and_b32_dpp v17, v28, v9 row_newbcast:7 row_mask:0xf bank_mask:0xf
    s_waitcnt vmcnt(15)
    s_add_u32 s67, s68, s70
    buffer_load_dwordx4 a[244:247], v1, s[40:43], s67 offen nt
    s_add_u32 s70, s70, 1024
    s_and_b32 s70, s70, 0xfc00
    v_mfma_f32_16x16x32_bf16 v[22:25], v[14:17], a[184:187], v[22:25]
    v_and_b32_dpp v18, v27, v6 row_newbcast:3 row_mask:0xf bank_mask:0xf
    v_and_b32_dpp v19, v27, v7 row_newbcast:3 row_mask:0xf bank_mask:0xf
    v_and_b32_dpp v20, v27, v8 row_newbcast:3 row_mask:0xf bank_mask:0xf
    v_and_b32_dpp v21, v27, v9 row_newbcast:3 row_mask:0xf bank_mask:0xf
    s_nop 1
    v_mfma_f32_16x16x32_bf16 v[22:25], v[18:21], a[112:115], v[22:25]
    v_and_b32_dpp v14, v27, v6 row_newbcast:11 row_mask:0xf bank_mask:0xf
    v_and_b32_dpp v15, v27, v7 row_newbcast:11 row_mask:0xf bank_mask:0xf
    v_and_b32_dpp v16, v27, v8 row_newbcast:11 row_mask:0xf bank_mask:0xf
    v_and_b32_dpp v17, v27, v9 row_newbcast:11 row_mask:0xf bank_mask:0xf
    s_nop 1
    v_mfma_f32_16x16x32_bf16 v[22:25], v[14:17], a[116:119], v[22:25]
    v_and_b32_dpp v18, v28, v6 row_newbcast:15 row_mask:0xf bank_mask:0xf
    v_and_b32_dpp v19, v28, v7 row_newbcast:15 row_mask:0xf bank_mask:0xf
    v_and_b32_dpp v20, v28, v8 row_newbcast:15 row_mask:0xf bank_mask:0xf
    v_and_b32_dpp v21, v28, v9 row_newbcast:15 row_mask:0xf bank_mask:0xf
    s_waitcnt vmcnt(15)
    s_add_u32 s67, s68, s70
    buffer_load_dwordx4 a[248:251], v1, s[40:43], s67 offen nt
    s_add_u32 s70, s70, 1024
    s_and_b32 s70, s70, 0xfc00
    v_mfma_f32_16x16x32_bf16 v[22:25], v[18:21], a[188:191], v[22:25]
    v_and_b32_dpp v14, v27, v6 row_newbcast:7 row_mask:0xf bank_mask:0xf
    v_and_b32_dpp v15, v27, v7 row_newbcast:7 row_mask:0xf bank_mask:0xf
    v_and_b32_dpp v16, v27, v8 row_newbcast:7 row_mask:0xf bank_mask:0xf
    v_and_b32_dpp v17, v27, v9 row_newbcast:7 row_mask:0xf bank_mask:0xf
    s_nop 1
    v_mfma_f32_16x16x32_bf16 v[22:25], v[14:17], a[120:123], v[22:25]
    v_and_b32_dpp v18, v27, v6 row_newbcast:15 row_mask:0xf bank_mask:0xf
    v_and_b32_dpp v19, v27, v7 row_newbcast:15 row_mask:0xf bank_mask:0xf
    v_and_b32_dpp v20, v27, v8 row_newbcast:15 row_mask:0xf bank_mask:0xf
    v_and_b32_dpp v21, v27, v9 row_newbcast:15 row_mask:0xf bank_mask:0xf
    s_nop 1
    v_mfma_f32_16x16x32_bf16 v[22:25], v[18:21], a[124:127], v[22:25]
    v_and_b32_dpp v14, v29, v6 row_newbcast:0 row_mask:0xf bank_mask:0xf
    v_and_b32_dpp v15, v29, v7 row_newbcast:0 row_mask:0xf bank_mask:0xf
    v_and_b32_dpp v16, v29, v8 row_newbcast:0 row_mask:0xf bank_mask:0xf
    v_and_b32_dpp v17, v29, v9 row_newbcast:0 row_mask:0xf bank_mask:0xf
    s_waitcnt vmcnt(15)
    s_add_u32 s67, s68, s70
    buffer_load_dwordx4 a[252:255], v1, s[40:43], s67 offen nt
    v_mfma_f32_16x16x32_bf16 v[22:25], v[14:17], a[192:195], v[22:25]
    v_and_b32_dpp v18, v29, v6 row_newbcast:8 row_mask:0xf bank_mask:0xf
    v_and_b32_dpp v19, v29, v7 row_newbcast:8 row_mask:0xf bank_mask:0xf
    v_and_b32_dpp v20, v29, v8 row_newbcast:8 row_mask:0xf bank_mask:0xf
    v_and_b32_dpp v21, v29, v9 row_newbcast:8 row_mask:0xf bank_mask:0xf
    s_waitcnt vmcnt(15)
    s_nop 0
    v_mfma_f32_16x16x32_bf16 v[22:25], v[18:21], a[196:199], v[22:25]
    v_and_b32_dpp v14, v29, v6 row_newbcast:4 row_mask:0xf bank_mask:0xf
    v_and_b32_dpp v15, v29, v7 row_newbcast:4 row_mask:0xf bank_mask:0xf
    v_and_b32_dpp v16, v29, v8 row_newbcast:4 row_mask:0xf bank_mask:0xf
    v_and_b32_dpp v17, v29, v9 row_newbcast:4 row_mask:0xf bank_mask:0xf
    s_waitcnt vmcnt(14)
    s_nop 0
    v_mfma_f32_16x16x32_bf16 v[22:25], v[14:17], a[200:203], v[22:25]
    v_and_b32_dpp v18, v29, v6 row_newbcast:12 row_mask:0xf bank_mask:0xf
    v_and_b32_dpp v19, v29, v7 row_newbcast:12 row_mask:0xf bank_mask:0xf
    v_and_b32_dpp v20, v29, v8 row_newbcast:12 row_mask:0xf bank_mask:0xf
    v_and_b32_dpp v21, v29, v9 row_newbcast:12 row_mask:0xf bank_mask:0xf
    s_waitcnt vmcnt(13)
    s_nop 0
    v_mfma_f32_16x16x32_bf16 v[22:25], v[18:21], a[204:207], v[22:25]
    v_and_b32_dpp v14, v29, v6 row_newbcast:2 row_mask:0xf bank_mask:0xf
    v_and_b32_dpp v15, v29, v7 row_newbcast:2 row_mask:0xf bank_mask:0xf
    v_and_b32_dpp v16, v29, v8 row_newbcast:2 row_mask:0xf bank_mask:0xf
    v_and_b32_dpp v17, v29, v9 row_newbcast:2 row_mask:0xf bank_mask:0xf
    s_waitcnt vmcnt(12)
    s_nop 0
    v_mfma_f32_16x16x32_bf16 v[22:25], v[14:17], a[208:211], v[22:25]
    v_and_b32_dpp v18, v29, v6 row_newbcast:10 row_mask:0xf bank_mask:0xf
    v_and_b32_dpp v19, v29, v7 row_newbcast:10 row_mask:0xf bank_mask:0xf
    v_and_b32_dpp v20, v29, v8 row_newbcast:10 row_mask:0xf bank_mask:0xf
    v_and_b32_dpp v21, v29, v9 row_newbcast:10 row_mask:0xf bank_mask:0xf
    s_waitcnt vmcnt(10)
    s_nop 0
    v_mfma_f32_16x16x32_bf16 v[22:25], v[18:21], a[212:215], v[22:25]
    s_cmp_lg_u32 s61, 0
    s_cbranch_scc1 L_noml
L_cnt:
    v_readfirstlane_b32 s65, v30
    s_cmp_ge_u32 s65, 128
    s_cbranch_scc1 L_cntok
    s_lshl_b32 s65, s62, 7
    v_mov_b32 v5, 0
    buffer_load_dword v30, v5, s[56:59], s65 offen sc1
    s_waitcnt vmcnt(0)
    s_branch L_cnt
L_cntok:
    s_mov_b32 s66, 524288
    buffer_load_dwordx2 v[44:45], v42, s[52:55], s66 offen offset:0 sc1
    buffer_load_dwordx2 v[46:47], v42, s[52:55], s66 offen offset:1024 sc1
L_noml:
    v_and_b32_dpp v14, v29, v6 row_newbcast:6 row_mask:0xf bank_mask:0xf
    v_and_b32_dpp v15, v29, v7 row_newbcast:6 row_mask:0xf bank_mask:0xf
    v_and_b32_dpp v16, v29, v8 row_newbcast:6 row_mask:0xf bank_mask:0xf
    v_and_b32_dpp v17, v29, v9 row_newbcast:6 row_mask:0xf bank_mask:0xf
    s_waitcnt vmcnt(9)
    s_nop 0
    v_mfma_f32_16x16x32_bf16 v[22:25], v[14:17], a[216:219], v[22:25]
    v_and_b32_dpp v18, v29, v6 row_newbcast:14 row_mask:0xf bank_mask:0xf
    v_and_b32_dpp v19, v29, v7 row_newbcast:14 row_mask:0xf bank_mask:0xf
    v_and_b32_dpp v20, v29, v8 row_newbcast:14 row_mask:0xf bank_mask:0xf
    v_and_b32_dpp v21, v29, v9 row_newbcast:14 row_mask:0xf bank_mask:0xf
    s_waitcnt vmcnt(8)
    s_nop 0
    v_mfma_f32_16x16x32_bf16 v[22:25], v[18:21], a[220:223], v[22:25]
    v_and_b32_dpp v14, v29, v6 row_newbcast:1 row_mask:0xf bank_mask:0xf
    v_and_b32_dpp v15, v29, v7 row_newbcast:1 row_mask:0xf bank_mask:0xf
    v_and_b32_dpp v16, v29, v8 row_newbcast:1 row_mask:0xf bank_mask:0xf
    v_and_b32_dpp v17, v29, v9 row_newbcast:1 row_mask:0xf bank_mask:0xf
    s_waitcnt vmcnt(7)
    s_nop 0
    v_mfma_f32_16x16x32_bf16 v[22:25], v[14:17], a[224:227], v[22:25]
    v_and_b32_dpp v18, v29, v6 row_newbcast:9 row_mask:0xf bank_mask:0xf
    v_and_b32_dpp v19, v29, v7 row_newbcast:9 row_mask:0xf bank_mask:0xf
    v_and_b32_dpp v20, v29, v8 row_newbcast:9 row_mask:0xf bank_mask:0xf
    v_and_b32_dpp v21, v29, v9 row_newbcast:9 row_mask:0xf bank_mask:0xf
    s_waitcnt vmcnt(6)
    s_nop 0
    v_mfma_f32_16x16x32_bf16 v[22:25], v[18:21], a[228:231], v[22:25]
    v_and_b32_dpp v14, v29, v6 row_newbcast:5 row_mask:0xf bank_mask:0xf
    v_and_b32_dpp v15, v29, v7 row_newbcast:5 row_mask:0xf bank_mask:0xf
    v_and_b32_dpp v16, v29, v8 row_newbcast:5 row_mask:0xf bank_mask:0xf
    v_and_b32_dpp v17, v29, v9 row_newbcast:5 row_mask:0xf bank_mask:0xf
    s_waitcnt vmcnt(5)
    s_nop 0
    v_mfma_f32_16x16x32_bf16 v[22:25], v[14:17], a[232:235], v[22:25]
    v_and_b32_dpp v18, v29, v6 row_newbcast:13 row_mask:0xf bank_mask:0xf
    v_and_b32_dpp v19, v29, v7 row_newbcast:13 row_mask:0xf bank_mask:0xf
    v_and_b32_dpp v20, v29, v8 row_newbcast:13 row_mask:0xf bank_mask:0xf
    v_and_b32_dpp v21, v29, v9 row_newbcast:13 row_mask:0xf bank_mask:0xf
    s_waitcnt vmcnt(4)
    s_nop 0
    v_mfma_f32_16x16x32_bf16 v[22:25], v[18:21], a[236:239], v[22:25]
    v_and_b32_dpp v14, v29, v6 row_newbcast:3 row_mask:0xf bank_mask:0xf
    v_and_b32_dpp v15, v29, v7 row_newbcast:3 row_mask:0xf bank_mask:0xf
    v_and_b32_dpp v16, v29, v8 row_newbcast:3 row_mask:0xf bank_mask:0xf
    v_and_b32_dpp v17, v29, v9 row_newbcast:3 row_mask:0xf bank_mask:0xf
    s_waitcnt vmcnt(3)
    s_nop 0
    v_mfma_f32_16x16x32_bf16 v[22:25], v[14:17], a[240:243], v[22:25]
    v_and_b32_dpp v18, v29, v6 row_newbcast:11 row_mask:0xf bank_mask:0xf
    v_and_b32_dpp v19, v29, v7 row_newbcast:11 row_mask:0xf bank_mask:0xf
    v_and_b32_dpp v20, v29, v8 row_newbcast:11 row_mask:0xf bank_mask:0xf
    v_and_b32_dpp v21, v29, v9 row_newbcast:11 row_mask:0xf bank_mask:0xf
    s_waitcnt vmcnt(2)
    s_nop 0
    v_mfma_f32_16x16x32_bf16 v[22:25], v[18:21], a[244:247], v[22:25]
    v_and_b32_dpp v14, v29, v6 row_newbcast:7 row_mask:0xf bank_mask:0xf
    v_and_b32_dpp v15, v29, v7 row_newbcast:7 row_mask:0xf bank_mask:0xf
    v_and_b32_dpp v16, v29, v8 row_newbcast:7 row_mask:0xf bank_mask:0xf
    v_and_b32_dpp v17, v29, v9 row_newbcast:7 row_mask:0xf bank_mask:0xf
    s_waitcnt vmcnt(1)
    s_nop 0
    v_mfma_f32_16x16x32_bf16 v[22:25], v[14:17], a[248:251], v[22:25]
    v_and_b32_dpp v18, v29, v6 row_newbcast:15 row_mask:0xf bank_mask:0xf
    v_and_b32_dpp v19, v29, v7 row_newbcast:15 row_mask:0xf bank_mask:0xf
    v_and_b32_dpp v20, v29, v8 row_newbcast:15 row_mask:0xf bank_mask:0xf
    v_and_b32_dpp v21, v29, v9 row_newbcast:15 row_mask:0xf bank_mask:0xf
    s_waitcnt vmcnt(0)
    s_nop 0
    v_mfma_f32_16x16x32_bf16 v[22:25], v[18:21], a[252:255], v[22:25]
    s_mov_b32 exec_hi, 0
    s_nop 6
    ds_write_b128 v38, v[22:25] offset:2304
    s_mov_b32 exec_hi, -1
    s_waitcnt lgkmcnt(0)
    s_barrier
    ds_read2st64_b64 v[80:83], v39 offset0:0 offset1:1
    ds_read2st64_b64 v[84:87], v39 offset0:2 offset1:3
    s_waitcnt lgkmcnt(1)
    v_pk_add_f32 v[80:81], v[80:81], v[82:83]
    s_waitcnt lgkmcnt(0)
    v_pk_add_f32 v[84:85], v[84:85], v[86:87]
    v_pk_add_f32 v[80:81], v[80:81], v[84:85]
    v_cvt_pk_bf16_f32 v4, v80, v81
    s_nop 1
    v_mov_b32_dpp v88, v4 row_newbcast:0 row_mask:0xf bank_mask:0xf
    v_mov_b32_dpp v89, v4 row_newbcast:1 row_mask:0xf bank_mask:0xf
    v_mov_b32_dpp v90, v4 row_newbcast:2 row_mask:0xf bank_mask:0xf
    v_mov_b32_dpp v91, v4 row_newbcast:3 row_mask:0xf bank_mask:0xf
    s_nop 1
    v_mfma_f32_16x16x32_bf16 v[48:51], v[88:91], v[128:131], 0
    v_mov_b32_dpp v92, v4 row_newbcast:4 row_mask:0xf bank_mask:0xf
    v_mfma_f32_16x16x32_bf16 v[52:55], v[88:91], v[132:135], 0
    v_mov_b32_dpp v93, v4 row_newbcast:5 row_mask:0xf bank_mask:0xf
    v_mfma_f32_16x16x32_bf16 v[56:59], v[88:91], v[136:139], 0
    v_mov_b32_dpp v94, v4 row_newbcast:6 row_mask:0xf bank_mask:0xf
    v_mfma_f32_16x16x32_bf16 v[60:63], v[88:91], v[140:143], 0
    v_mov_b32_dpp v95, v4 row_newbcast:7 row_mask:0xf bank_mask:0xf
    v_mfma_f32_16x16x32_bf16 v[64:67], v[88:91], v[144:147], 0
    v_mfma_f32_16x16x32_bf16 v[68:71], v[88:91], v[148:151], 0
    v_mfma_f32_16x16x32_bf16 v[72:75], v[88:91], v[152:155], 0
    v_mfma_f32_16x16x32_bf16 v[76:79], v[88:91], v[156:159], 0
    v_mfma_f32_16x16x32_bf16 v[48:51], v[92:95], v[160:163], v[48:51]
    v_mov_b32_dpp v96, v4 row_newbcast:8 row_mask:0xf bank_mask:0xf
    v_mfma_f32_16x16x32_bf16 v[52:55], v[92:95], v[164:167], v[52:55]
    v_mov_b32_dpp v97, v4 row_newbcast:9 row_mask:0xf bank_mask:0xf
    v_mfma_f32_16x16x32_bf16 v[56:59], v[92:95], v[168:171], v[56:59]
    v_mov_b32_dpp v98, v4 row_newbcast:10 row_mask:0xf bank_mask:0xf
    v_mfma_f32_16x16x32_bf16 v[60:63], v[92:95], v[172:175], v[60:63]
    v_mov_b32_dpp v99, v4 row_newbcast:11 row_mask:0xf bank_mask:0xf
    v_mfma_f32_16x16x32_bf16 v[64:67], v[92:95], v[176:179], v[64:67]
    v_mfma_f32_16x16x32_bf16 v[68:71], v[92:95], v[180:183], v[68:71]
    v_mfma_f32_16x16x32_bf16 v[72:75], v[92:95], v[184:187], v[72:75]
    v_mfma_f32_16x16x32_bf16 v[76:79], v[92:95], v[188:191], v[76:79]
    v_mfma_f32_16x16x32_bf16 v[48:51], v[96:99], v[192:195], v[48:51]
    v_mov_b32_dpp v100, v4 row_newbcast:12 row_mask:0xf bank_mask:0xf
    v_mfma_f32_16x16x32_bf16 v[52:55], v[96:99], v[196:199], v[52:55]
    v_mov_b32_dpp v101, v4 row_newbcast:13 row_mask:0xf bank_mask:0xf
    v_mfma_f32_16x16x32_bf16 v[56:59], v[96:99], v[200:203], v[56:59]
    v_mov_b32_dpp v102, v4 row_newbcast:14 row_mask:0xf bank_mask:0xf
    v_mfma_f32_16x16x32_bf16 v[60:63], v[96:99], v[204:207], v[60:63]
    v_mov_b32_dpp v103, v4 row_newbcast:15 row_mask:0xf bank_mask:0xf
    v_mfma_f32_16x16x32_bf16 v[64:67], v[96:99], v[208:211], v[64:67]
    v_mfma_f32_16x16x32_bf16 v[68:71], v[96:99], v[212:215], v[68:71]
    v_mfma_f32_16x16x32_bf16 v[72:75], v[96:99], v[216:219], v[72:75]
    v_mfma_f32_16x16x32_bf16 v[76:79], v[96:99], v[220:223], v[76:79]
    v_mfma_f32_16x16x32_bf16 v[48:51], v[100:103], v[224:227], v[48:51]
    v_mfma_f32_16x16x32_bf16 v[52:55], v[100:103], v[228:231], v[52:55]
    v_mfma_f32_16x16x32_bf16 v[56:59], v[100:103], v[232:235], v[56:59]
    v_mfma_f32_16x16x32_bf16 v[60:63], v[100:103], v[236:239], v[60:63]
    v_mfma_f32_16x16x32_bf16 v[64:67], v[100:103], v[240:243], v[64:67]
    v_mfma_f32_16x16x32_bf16 v[68:71], v[100:103], v[244:247], v[68:71]
    v_mfma_f32_16x16x32_bf16 v[72:75], v[100:103], v[248:251], v[72:75]
    v_mfma_f32_16x16x32_bf16 v[76:79], v[100:103], v[252:255], v[76:79]
    s_nop 3
    v_min_u32 v80, -2, v48
    v_min_u32 v81, -2, v52
    v_min_u32 v82, -2, v56
    v_min_u32 v83, -2, v60
    s_mov_b32 exec_lo, 0xffff0000
    v_min_u32 v80, -2, v64
    v_min_u32 v81, -2, v68
    v_min_u32 v82, -2, v72
    v_min_u32 v83, -2, v76
    s_mov_b32 exec_lo, -1
    s_mov_b32 exec_hi, 0
    buffer_store_dwordx4 v[80:83], v40, s[52:55], s77 offen sc1
    s_mov_b32 exec_hi, -1
    s_cmp_lg_u32 s61, 0
    s_cbranch_scc1 L_end
    s_add_u32 s67, s82, 32768
    buffer_load_dwordx4 v[96:99], v41, s[52:55], s82 offen sc1
    buffer_load_dwordx4 v[100:103], v41, s[52:55], s67 offen sc1
L_ml:
    v_max3_u32 v4, v44, v45, v46
    v_max_u32 v4, v4, v47
    v_cmp_eq_u32 vcc, -1, v4
    s_cbranch_vccz L_mlok
    buffer_load_dwordx2 v[44:45], v42, s[52:55], s66 offen offset:0 sc1
    buffer_load_dwordx2 v[46:47], v42, s[52:55], s66 offen offset:1024 sc1
    s_waitcnt vmcnt(0)
    s_branch L_ml
L_mlok:
    v_max_f32_dpp v104, v44, v44 row_ror:4 row_mask:0xf bank_mask:0xf
    v_max_f32_dpp v105, v46, v46 row_ror:4 row_mask:0xf bank_mask:0xf
    s_nop 0
    v_max_f32_dpp v104, v104, v104 row_ror:8 row_mask:0xf bank_mask:0xf
    v_max_f32_dpp v105, v105, v105 row_ror:8 row_mask:0xf bank_mask:0xf
    s_nop 0
    v_sub_f32 v104, v44, v104
    v_sub_f32 v105, v46, v105
    v_mul_f32 v104, 0x3fb8aa3b, v104
    v_mul_f32 v105, 0x3fb8aa3b, v105
    v_exp_f32 v104, v104
    v_exp_f32 v105, v105
    s_nop 0
    v_mul_f32 v106, v104, v45
    v_mul_f32 v107, v105, v47
    s_nop 0
    v_add_f32_dpp v106, v106, v106 row_ror:8 row_mask:0xf bank_mask:0xf
    v_add_f32_dpp v107, v107, v107 row_ror:8 row_mask:0xf bank_mask:0xf
    s_nop 0
    v_add_f32_dpp v106, v106, v106 row_ror:4 row_mask:0xf bank_mask:0xf
    v_add_f32_dpp v107, v107, v107 row_ror:4 row_mask:0xf bank_mask:0xf
    s_nop 0
    v_add_f32_dpp v106, v106, v106 row_ror:2 row_mask:0xf bank_mask:0xf
    v_add_f32_dpp v107, v107, v107 row_ror:2 row_mask:0xf bank_mask:0xf
    s_nop 0
    v_add_f32_dpp v106, v106, v106 row_ror:1 row_mask:0xf bank_mask:0xf
    v_add_f32_dpp v107, v107, v107 row_ror:1 row_mask:0xf bank_mask:0xf
    v_rcp_f32 v106, v106
    v_rcp_f32 v107, v107
    s_nop 0
    v_mul_f32 v104, v104, v106
    v_mul_f32 v105, v105, v107
    s_branch L_chk
L_poll:
    buffer_load_dwordx4 v[96:99], v41, s[52:55], s82 offen sc1
    buffer_load_dwordx4 v[100:103], v41, s[52:55], s67 offen sc1
L_chk:
    s_waitcnt vmcnt(0)
    v_max3_u32 v4, v96, v97, v98
    v_max3_u32 v5, v99, v100, v101
    v_max3_u32 v4, v4, v102, v103
    v_max_u32 v4, v4, v5
    v_cmp_eq_u32 vcc, -1, v4
    s_mov_b64 exec, vcc
    s_cbranch_execnz L_poll
    s_mov_b64 exec, -1
    v_mul_f32 v96, v96, v104
    v_mul_f32 v97, v97, v104
    v_mul_f32 v98, v98, v104
    v_mul_f32 v99, v99, v104
    v_fmac_f32 v96, v100, v105
    v_fmac_f32 v97, v101, v105
    v_fmac_f32 v98, v102, v105
    v_fmac_f32 v99, v103, v105
    s_nop 0
    v_permlane16_swap_b32 v96, v97
    v_permlane16_swap_b32 v98, v99
    v_add_f32 v96, v96, v97
    v_add_f32 v98, v98, v99
    s_nop 1
    v_permlane32_swap_b32 v96, v98
    v_add_f32 v96, v96, v98
    s_nop 1
    v_add_f32_dpp v96, v96, v96 row_ror:4 row_mask:0xf bank_mask:0xf
    s_nop 1
    v_add_f32_dpp v96, v96, v96 row_ror:8 row_mask:0xf bank_mask:0xf
    ds_write_b32 v43, v96 offset:4352
    v_lshlrev_b32 v4, 1, v0
    s_waitcnt lgkmcnt(0)
    s_barrier
    s_cmp_lg_u32 s63, 0
    s_cbranch_scc1 L_end
    s_mov_b64 exec, 0xffff
    ds_read_b128 v[96:99], v1 offset:4352
    s_waitcnt lgkmcnt(0)
    v_pk_add_f32 v[96:97], v[96:97], v[98:99]
    v_add_f32 v96, v96, v97
    v_cvt_pk_bf16_f32 v96, v96, v96
    buffer_store_short v96, v4, s[84:87], s83 offen
L_end:
    s_endpgm
.section .rodata,"a"
.p2align 6
.amdhsa_kernel concat_heads__gqa_block_cached__gqa_block_cached__decode_kernel
  .amdhsa_next_free_vgpr 512
  .amdhsa_next_free_sgpr 102
  .amdhsa_accum_offset 256
  .amdhsa_group_segment_fixed_size 0
  .amdhsa_kernarg_size 104
  .amdhsa_user_sgpr_count 2
  .amdhsa_user_sgpr_kernarg_segment_ptr 1
  .amdhsa_system_sgpr_workgroup_id_x 1
.end_amdhsa_kernel
```
